```python
import torch

def _softmax(x, axis=-1):
    return torch.softmax(x, dim=axis)

def _gelu(x):
    return torch.nn.functional.gelu(x, approximate='tanh')

def _silu(x):
    return torch.nn.functional.silu(x)

def _sigmoid(x):
    return torch.sigmoid(x)

def _layernorm(x, axis=-1, eps=1e-05):
    m = x.mean(dim=axis, keepdim=True)
    v = x.var(dim=axis, keepdim=True, unbiased=False)
    return (x - m) / torch.sqrt(v + eps)

def _scatter_add(tgt, idx, src, axis=0):
    return tgt.clone().index_add_(axis, idx, src)

def _segment_sum(src, seg, n):
    out = torch.zeros((n,) + src.shape[1:], dtype=src.dtype)
    return out.index_add_(0, seg, src)

def _pad(x, pw):
    flat = tuple((v for pair in reversed(pw) for v in pair))
    return torch.nn.functional.pad(x, flat)
kernel_name = 'adaLN_cond__sliding_block_cached__swiglu_ffn__decode'

def setup_inputs():

    _w = lambda a: (lambda t: t.to(torch.bfloat16) if t.is_floating_point() else t)(torch.as_tensor(a))

    def _A_setup():
        B, Sq, D = (4, 1, 512)
        Hq, Hkv, Sk, Dh = (32, 8, 4096, 128)
        assert Hq % Hkv == 0, (Hq, Hkv)
        return {'x': _w((lambda *s: torch.randn(*s, dtype=torch.bfloat16) * 0.05)(B, Sq, D)), 'k_cache': _w((lambda *s: torch.randn(*s, dtype=torch.bfloat16) * 3.2)(B, Hkv, Sk, Dh)), 'v_cache': _w((lambda *s: torch.randn(*s, dtype=torch.bfloat16) * 0.4)(B, Hkv, Sk, Dh)), 'wq': _w((lambda *s: torch.randn(*s, dtype=torch.bfloat16) * 3.2)(D, Hq * Dh) * D ** (-0.5)), 'wo': _w((lambda *s: torch.randn(*s, dtype=torch.bfloat16) * 0.4)(Hq * Dh, D) * (Hq * Dh) ** (-0.5))}
    _A_in = _A_setup()

    def _B_setup():
        B, S, D, F = (4, 1, 512, 1792)
        return {'x': _w((lambda *s: torch.randn(*s, dtype=torch.bfloat16) * 0.05)(B, S, D)), 'w_gate': _w((lambda *s: torch.randn(*s, dtype=torch.bfloat16) * 0.05)(D, F)), 'w_up': _w((lambda *s: torch.randn(*s, dtype=torch.bfloat16) * 0.05)(D, F)), 'w_down': _w((lambda *s: torch.randn(*s, dtype=torch.bfloat16) * 0.05)(F, D))}
    _B_in = _B_setup()
    return {'A_x': _A_in['x'], 'A_k_cache': _A_in['k_cache'], 'A_v_cache': _A_in['v_cache'], 'A_wq': _A_in['wq'], 'A_wo': _A_in['wo'], 'B_x': _B_in['x'], 'B_w_gate': _B_in['w_gate'], 'B_w_up': _B_in['w_up'], 'B_w_down': _B_in['w_down'], 'c': _w((lambda *s: torch.randn(*s, dtype=torch.bfloat16) * 0.1)(4, 512) * 8.0), 'w_mod': _w((lambda *s: torch.randn(*s, dtype=torch.bfloat16) * 0.1)(512, 6 * 512) * 512 ** (-0.5) * 8.0)}

def reference(A_x, A_k_cache, A_v_cache, A_wq, A_wo, B_x, B_w_gate, B_w_up, B_w_down, c, w_mod):

    def _A_ref(x, k_cache, v_cache, wq, wo):
        B, Sq, D = x.shape
        Hq, Dh = (32, 128)
        Hkv, Sk = (k_cache.shape[1], k_cache.shape[2])
        W = min(4096, max(256, Sk // 4))
        rep = Hq // Hkv
        q = (lambda x, *d: x.permute(*d))((x @ wq).reshape(B, Sq, Hq, Dh), 0, 2, 1, 3)
        k = (lambda x, n, axis: torch.repeat_interleave(x, n, dim=axis))(k_cache[:, :, Sk - W:, :], rep, axis=1)
        v = (lambda x, n, axis: torch.repeat_interleave(x, n, dim=axis))(v_cache[:, :, Sk - W:, :], rep, axis=1)
        scores = torch.einsum('bhqd,bhkd->bhqk', q, k) * Dh ** (-0.5)
        p = _softmax(scores, axis=-1)
        o = torch.einsum('bhqk,bhkd->bhqd', p, v)
        return (lambda x, *d: x.permute(*d))(o, 0, 2, 1, 3).reshape(B, Sq, Hq * Dh) @ wo

    def _B_ref(x, w_gate, w_up, w_down):
        g = _silu(x @ w_gate)
        u = x @ w_up
        return g * u @ w_down
    x = A_x
    mod = (_silu(c) @ w_mod).reshape(c.shape[0], 6, 1, -1)
    sa, ca, ga, sb, cb, gb = (mod[:, 0].clone(), mod[:, 1].clone(), mod[:, 2].clone(), mod[:, 3].clone(), mod[:, 4].clone(), mod[:, 5].clone())
    h = _layernorm(x, axis=-1) * (1 + ca) + sa
    x = x + ga * _A_ref(h, A_k_cache, A_v_cache, A_wq, A_wo)
    h = _layernorm(x, axis=-1) * (1 + cb) + sb
    x = x + gb * _B_ref(h, B_w_gate, B_w_up, B_w_down)
    return x
```

```asm
; @launch grid=(256,1,1) block=(512,1,1) lds=160000
.amdgcn_target "amdgcn-amd-amdhsa--gfx950"
.text
.globl adaLN_cond__sliding_block_cached__swiglu_ffn__decode_kernel
.p2align 12
L_code0:
L_WO:
    s_lshr_b32 s40, s3, 1
    s_lshl3_add_u32 s99, s14, s3
    s_lshl_b32 s99, s99, 10
    s_add_u32 s99, s99, s15
    s_lshl_b32 s99, s99, 6
    s_add_u32 s34, s99, 0x1000
    s_add_u32 s34, s12, s34
    s_addc_u32 s35, s13, 0
    v_and_b32 v9, 15, v0
    v_lshlrev_b32 v6, 13, v3
    v_lshl_add_u32 v6, v9, 2, v6
    v_add_u32 v11, 0x8000, v6
    s_movk_i32 s42, 8192
    s_lshl3_add_u32 s99, s14, s3
    s_lshl_b32 s99, s99, 11
    s_add_u32 s32, s99, 0x73000
    s_add_u32 s32, s30, s32
    s_addc_u32 s33, s31, 0
    v_lshlrev_b32 v5, 4, v0
    s_lshr_b32 s41, s15, 1
    s_barrier
    s_cmp_lg_u32 s3, s41
    s_cbranch_scc1 L_WOt
    global_load_dwordx4 v[64:67], v5, s[32:33] sc1
    global_load_dwordx4 v[68:71], v5, s[32:33] offset:1024 sc1
L_WOt:
    s_cmp_ge_u32 s3, 1
    s_cbranch_scc1 L_wp1
    s_mul_i32 s99, s41, 1
    s_add_u32 s99, s99, s3
    s_lshl_b32 s43, s14, 6
    s_add_u32 s99, s99, s43
    s_add_u32 s99, s99, 56
    s_lshl_b32 s99, s99, 13
    v_lshl_add_u32 v8, v0, 7, s99
    global_load_dword v127, v8, s[12:13]
L_wp1:
    global_load_dword v128, v6, s[34:35] offset:-4096
    global_load_dword v136, v6, s[34:35] offset:-4032
    global_load_dword v144, v11, s[34:35] offset:-4096
    global_load_dword v152, v11, s[34:35] offset:-4032
    global_load_dword v129, v6, s[34:35] offset:-3072
    global_load_dword v137, v6, s[34:35] offset:-3008
    global_load_dword v145, v11, s[34:35] offset:-3072
    global_load_dword v153, v11, s[34:35] offset:-3008
    global_load_dword v130, v6, s[34:35] offset:-2048
    global_load_dword v138, v6, s[34:35] offset:-1984
    global_load_dword v146, v11, s[34:35] offset:-2048
    global_load_dword v154, v11, s[34:35] offset:-1984
    global_load_dword v131, v6, s[34:35] offset:-1024
    global_load_dword v139, v6, s[34:35] offset:-960
    global_load_dword v147, v11, s[34:35] offset:-1024
    global_load_dword v155, v11, s[34:35] offset:-960
    global_load_dword v132, v6, s[34:35] offset:0
    global_load_dword v140, v6, s[34:35] offset:64
    global_load_dword v148, v11, s[34:35] offset:0
    global_load_dword v156, v11, s[34:35] offset:64
    global_load_dword v133, v6, s[34:35] offset:1024
    global_load_dword v141, v6, s[34:35] offset:1088
    global_load_dword v149, v11, s[34:35] offset:1024
    global_load_dword v157, v11, s[34:35] offset:1088
    global_load_dword v134, v6, s[34:35] offset:2048
    global_load_dword v142, v6, s[34:35] offset:2112
    global_load_dword v150, v11, s[34:35] offset:2048
    global_load_dword v158, v11, s[34:35] offset:2112
    global_load_dword v135, v6, s[34:35] offset:3072
    global_load_dword v143, v6, s[34:35] offset:3136
    global_load_dword v151, v11, s[34:35] offset:3072
    global_load_dword v159, v11, s[34:35] offset:3136
    s_lshl2_add_u32 s99, s14, s40
    s_lshl_b32 s99, s99, 7
    s_add_u32 s36, s99, 0x72000
    s_add_u32 s36, s30, s36
    s_addc_u32 s37, s31, 0
    v_lshlrev_b32 v6, 5, v3
    v_lshlrev_b32 v12, 8, v3
    v_lshl_add_u32 v12, v9, 3, v12
    v_lshl_add_u32 v12, s3, 10, v12
    s_lshl4_add_u32 s99, s14, s15
    s_lshl1_add_u32 s99, s99, s3
    s_lshl_b32 s99, s99, 7
    s_add_u32 s34, s99, 0x64000
    s_add_u32 s34, s30, s34
    s_addc_u32 s35, s31, 0
    v_and_b32 v13, 16, v0
    v_lshlrev_b32 v13, 4, v13
    v_and_b32 v10, 32, v0
    v_lshl_add_u32 v13, v10, 1, v13
    v_lshl_add_u32 v13, v9, 2, v13
    s_waitcnt vmcnt(0)
    v_perm_b32 v32, v129, v128, s96
    v_perm_b32 v33, v131, v130, s96
    v_perm_b32 v34, v133, v132, s96
    v_perm_b32 v35, v135, v134, s96
    v_perm_b32 v36, v129, v128, s97
    v_perm_b32 v37, v131, v130, s97
    v_perm_b32 v38, v133, v132, s97
    v_perm_b32 v39, v135, v134, s97
    v_perm_b32 v40, v137, v136, s96
    v_perm_b32 v41, v139, v138, s96
    v_perm_b32 v42, v141, v140, s96
    v_perm_b32 v43, v143, v142, s96
    v_perm_b32 v44, v137, v136, s97
    v_perm_b32 v45, v139, v138, s97
    v_perm_b32 v46, v141, v140, s97
    v_perm_b32 v47, v143, v142, s97
    v_perm_b32 v48, v145, v144, s96
    v_perm_b32 v49, v147, v146, s96
    v_perm_b32 v50, v149, v148, s96
    v_perm_b32 v51, v151, v150, s96
    v_perm_b32 v52, v145, v144, s97
    v_perm_b32 v53, v147, v146, s97
    v_perm_b32 v54, v149, v148, s97
    v_perm_b32 v55, v151, v150, s97
    v_perm_b32 v56, v153, v152, s96
    v_perm_b32 v57, v155, v154, s96
    v_perm_b32 v58, v157, v156, s96
    v_perm_b32 v59, v159, v158, s96
    v_perm_b32 v60, v153, v152, s97
    v_perm_b32 v61, v155, v154, s97
    v_perm_b32 v62, v157, v156, s97
    v_perm_b32 v63, v159, v158, s97
    s_mov_b32 s98, 100000
L_poll2:
    global_load_dwordx4 v[72:75], v6, s[36:37] sc1
    global_load_dwordx4 v[76:79], v6, s[36:37] offset:16 sc1
    s_sub_u32 s98, s98, 1
    s_cselect_b64 s[38:39], 0, -1
    s_waitcnt vmcnt(0)
    v_max3_u32 v8, v72, v73, v74
    v_max3_u32 v8, v8, v75, v76
    v_max3_u32 v8, v8, v77, v78
    v_max_u32 v8, v8, v79
    v_cmp_eq_u32 vcc, -1, v8
    s_and_b64 vcc, vcc, s[38:39]
    s_cbranch_scc1 L_poll2
    global_load_dwordx4 v[64:67], v5, s[32:33] sc1
    global_load_dwordx4 v[68:71], v5, s[32:33] offset:1024 sc1
    v_max3_f32 v8, v72, v74, v76
    v_max_f32 v8, v8, v78
    v_sub_f32 v72, v72, v8
    v_sub_f32 v74, v74, v8
    v_sub_f32 v76, v76, v8
    v_sub_f32 v78, v78, v8
    v_exp_f32 v72, v72
    v_exp_f32 v74, v74
    v_exp_f32 v76, v76
    v_exp_f32 v78, v78
    v_mul_f32 v9, v72, v73
    v_fmac_f32 v9, v74, v75
    v_fmac_f32 v9, v76, v77
    v_fmac_f32 v9, v78, v79
    v_rcp_f32 v9, v9
    s_nop 0
    v_mul_f32 v80, v72, v9
    v_mul_f32 v81, v74, v9
    v_mul_f32 v82, v76, v9
    v_mul_f32 v83, v78, v9
    s_mov_b32 s98, 100000
    s_branch L_WO2
L_WO1:
    global_load_dwordx4 v[64:67], v5, s[32:33] sc1
    global_load_dwordx4 v[68:71], v5, s[32:33] offset:1024 sc1
L_WO2:
    s_sub_u32 s98, s98, 1
    s_cselect_b64 s[38:39], 0, -1
    s_waitcnt vmcnt(1)
    v_mfma_f32_16x16x32_bf16 v[16:19], v[64:67], v[32:35], 0
    v_max3_u32 v8, v64, v65, v66
    v_mfma_f32_16x16x32_bf16 v[20:23], v[64:67], v[36:39], 0
    s_waitcnt vmcnt(0)
    v_mfma_f32_16x16x32_bf16 v[16:19], v[68:71], v[48:51], v[16:19]
    v_max3_u32 v8, v8, v67, v68
    v_max3_u32 v8, v8, v69, v70
    v_mfma_f32_16x16x32_bf16 v[20:23], v[68:71], v[52:55], v[20:23]
    v_max_u32 v8, v8, v71
    v_cmp_eq_u32 vcc, -1, v8
    s_and_b64 vcc, vcc, s[38:39]
    s_cbranch_scc1 L_WO1
    v_mfma_f32_16x16x32_bf16 v[24:27], v[64:67], v[40:43], 0
    v_mfma_f32_16x16x32_bf16 v[28:31], v[64:67], v[44:47], 0
    v_mfma_f32_16x16x32_bf16 v[24:27], v[68:71], v[56:59], v[24:27]
    v_mfma_f32_16x16x32_bf16 v[28:31], v[68:71], v[60:63], v[28:31]
    v_pk_mul_f32 v[16:17], v[16:17], v[80:81]
    v_pk_fma_f32 v[16:17], v[18:19], v[82:83], v[16:17]
    v_pk_mul_f32 v[20:21], v[20:21], v[80:81]
    v_pk_fma_f32 v[20:21], v[22:23], v[82:83], v[20:21]
    v_add_f32 v84, v16, v17
    v_add_f32 v85, v20, v21
    ds_write_b64 v12, v[84:85] offset:0
    v_pk_mul_f32 v[24:25], v[24:25], v[80:81]
    v_pk_fma_f32 v[24:25], v[26:27], v[82:83], v[24:25]
    v_pk_mul_f32 v[28:29], v[28:29], v[80:81]
    v_pk_fma_f32 v[28:29], v[30:31], v[82:83], v[28:29]
    v_add_f32 v86, v24, v25
    v_add_f32 v87, v28, v29
    ds_write_b64 v12, v[86:87] offset:128
    s_waitcnt lgkmcnt(0)
    s_barrier
    s_cmp_ge_u32 s3, 2
    s_cbranch_scc1 L_fin
    ds_read2st64_b64 v[16:19], v7 offset0:0 offset1:2
    ds_read2st64_b64 v[20:23], v7 offset0:4 offset1:6
    ds_read2st64_b64 v[24:27], v7 offset0:8 offset1:10
    ds_read2st64_b64 v[28:31], v7 offset0:12 offset1:14
    s_waitcnt lgkmcnt(2)
    v_pk_add_f32 v[16:17], v[16:17], v[18:19]
    v_pk_add_f32 v[20:21], v[20:21], v[22:23]
    s_waitcnt lgkmcnt(1)
    v_pk_add_f32 v[24:25], v[24:25], v[26:27]
    v_pk_add_f32 v[16:17], v[16:17], v[20:21]
    s_waitcnt lgkmcnt(0)
    v_pk_add_f32 v[28:29], v[28:29], v[30:31]
    v_pk_add_f32 v[16:17], v[16:17], v[24:25]
    v_pk_add_f32 v[16:17], v[16:17], v[28:29]
    v_cvt_pk_bf16_f32 v8, v16, v17
    global_store_dword v13, v8, s[34:35] sc1
L_fin:
    s_endpgm
L_GQA2:
    s_mov_b32 s14, s40
    s_mov_b32 s15, s41
    s_mov_b32 s96, 0x05040100
    s_mov_b32 s97, 0x07060302
    s_cmp_lg_u32 s3, 7
    s_cbranch_scc1 L_GQA3
    s_waitcnt vmcnt(0)
    v_readfirstlane_b32 s28, v12
    s_nop 1
    s_mul_i32 s28, s28, 1664525
    s_add_u32 s28, s28, 1013904223
    v_lshlrev_b32 v16, 16, v80
    v_and_b32 v17, 0xffff0000, v80
    v_lshlrev_b32 v18, 16, v81
    v_and_b32 v19, 0xffff0000, v81
    v_lshlrev_b32 v20, 16, v82
    v_and_b32 v21, 0xffff0000, v82
    v_lshlrev_b32 v22, 16, v83
    v_and_b32 v23, 0xffff0000, v83
    v_lshlrev_b32 v24, 16, v84
    v_and_b32 v25, 0xffff0000, v84
    v_lshlrev_b32 v26, 16, v85
    v_and_b32 v27, 0xffff0000, v85
    v_lshlrev_b32 v28, 16, v86
    v_and_b32 v29, 0xffff0000, v86
    v_lshlrev_b32 v30, 16, v87
    v_and_b32 v31, 0xffff0000, v87
    v_lshlrev_b32 v32, 16, v88
    v_and_b32 v33, 0xffff0000, v88
    v_lshlrev_b32 v34, 16, v89
    v_and_b32 v35, 0xffff0000, v89
    v_lshlrev_b32 v36, 16, v90
    v_and_b32 v37, 0xffff0000, v90
    v_lshlrev_b32 v38, 16, v91
    v_and_b32 v39, 0xffff0000, v91
    v_lshlrev_b32 v40, 16, v92
    v_and_b32 v41, 0xffff0000, v92
    v_lshlrev_b32 v42, 16, v93
    v_and_b32 v43, 0xffff0000, v93
    v_lshlrev_b32 v44, 16, v94
    v_and_b32 v45, 0xffff0000, v94
    v_lshlrev_b32 v46, 16, v95
    v_and_b32 v47, 0xffff0000, v95
    v_pk_add_f32 v[8:9], v[16:17], v[18:19]
    v_pk_add_f32 v[8:9], v[8:9], v[20:21]
    v_pk_add_f32 v[8:9], v[8:9], v[22:23]
    v_pk_add_f32 v[8:9], v[8:9], v[24:25]
    v_pk_add_f32 v[8:9], v[8:9], v[26:27]
    v_pk_add_f32 v[8:9], v[8:9], v[28:29]
    v_pk_add_f32 v[8:9], v[8:9], v[30:31]
    v_pk_add_f32 v[8:9], v[8:9], v[32:33]
    v_pk_add_f32 v[8:9], v[8:9], v[34:35]
    v_pk_add_f32 v[8:9], v[8:9], v[36:37]
    v_pk_add_f32 v[8:9], v[8:9], v[38:39]
    v_pk_add_f32 v[8:9], v[8:9], v[40:41]
    v_pk_add_f32 v[8:9], v[8:9], v[42:43]
    v_pk_add_f32 v[8:9], v[8:9], v[44:45]
    v_pk_add_f32 v[8:9], v[8:9], v[46:47]
    v_add_f32 v8, v8, v9
    s_nop 1
    v_add_f32_dpp v8, v8, v8 row_ror:8 row_mask:0xf bank_mask:0xf
    s_nop 1
    v_add_f32_dpp v8, v8, v8 row_ror:4 row_mask:0xf bank_mask:0xf
    s_nop 1
    v_add_f32_dpp v8, v8, v8 row_ror:2 row_mask:0xf bank_mask:0xf
    s_nop 1
    v_add_f32_dpp v8, v8, v8 row_ror:1 row_mask:0xf bank_mask:0xf
    v_mul_f32 v8, 0x3b000000, v8
    v_mov_b32 v9, v8
    v_pk_add_f32 v[16:17], v[16:17], v[8:9] neg_lo:[0,1] neg_hi:[0,1]
    v_pk_add_f32 v[18:19], v[18:19], v[8:9] neg_lo:[0,1] neg_hi:[0,1]
    v_pk_add_f32 v[20:21], v[20:21], v[8:9] neg_lo:[0,1] neg_hi:[0,1]
    v_pk_add_f32 v[22:23], v[22:23], v[8:9] neg_lo:[0,1] neg_hi:[0,1]
    v_pk_add_f32 v[24:25], v[24:25], v[8:9] neg_lo:[0,1] neg_hi:[0,1]
    v_pk_add_f32 v[26:27], v[26:27], v[8:9] neg_lo:[0,1] neg_hi:[0,1]
    v_pk_add_f32 v[28:29], v[28:29], v[8:9] neg_lo:[0,1] neg_hi:[0,1]
    v_pk_add_f32 v[30:31], v[30:31], v[8:9] neg_lo:[0,1] neg_hi:[0,1]
    v_pk_add_f32 v[32:33], v[32:33], v[8:9] neg_lo:[0,1] neg_hi:[0,1]
    v_pk_add_f32 v[34:35], v[34:35], v[8:9] neg_lo:[0,1] neg_hi:[0,1]
    v_pk_add_f32 v[36:37], v[36:37], v[8:9] neg_lo:[0,1] neg_hi:[0,1]
    v_pk_add_f32 v[38:39], v[38:39], v[8:9] neg_lo:[0,1] neg_hi:[0,1]
    v_pk_add_f32 v[40:41], v[40:41], v[8:9] neg_lo:[0,1] neg_hi:[0,1]
    v_pk_add_f32 v[42:43], v[42:43], v[8:9] neg_lo:[0,1] neg_hi:[0,1]
    v_pk_add_f32 v[44:45], v[44:45], v[8:9] neg_lo:[0,1] neg_hi:[0,1]
    v_pk_add_f32 v[46:47], v[46:47], v[8:9] neg_lo:[0,1] neg_hi:[0,1]
    v_pk_mul_f32 v[10:11], v[16:17], v[16:17]
    v_pk_fma_f32 v[10:11], v[18:19], v[18:19], v[10:11]
    v_pk_fma_f32 v[10:11], v[20:21], v[20:21], v[10:11]
    v_pk_fma_f32 v[10:11], v[22:23], v[22:23], v[10:11]
    v_pk_fma_f32 v[10:11], v[24:25], v[24:25], v[10:11]
    v_pk_fma_f32 v[10:11], v[26:27], v[26:27], v[10:11]
    v_pk_fma_f32 v[10:11], v[28:29], v[28:29], v[10:11]
    v_pk_fma_f32 v[10:11], v[30:31], v[30:31], v[10:11]
    v_pk_fma_f32 v[10:11], v[32:33], v[32:33], v[10:11]
    v_pk_fma_f32 v[10:11], v[34:35], v[34:35], v[10:11]
    v_pk_fma_f32 v[10:11], v[36:37], v[36:37], v[10:11]
    v_pk_fma_f32 v[10:11], v[38:39], v[38:39], v[10:11]
    v_pk_fma_f32 v[10:11], v[40:41], v[40:41], v[10:11]
    v_pk_fma_f32 v[10:11], v[42:43], v[42:43], v[10:11]
    v_pk_fma_f32 v[10:11], v[44:45], v[44:45], v[10:11]
    v_pk_fma_f32 v[10:11], v[46:47], v[46:47], v[10:11]
    v_add_f32 v10, v10, v11
    s_nop 1
    v_add_f32_dpp v10, v10, v10 row_ror:8 row_mask:0xf bank_mask:0xf
    s_nop 1
    v_add_f32_dpp v10, v10, v10 row_ror:4 row_mask:0xf bank_mask:0xf
    s_nop 1
    v_add_f32_dpp v10, v10, v10 row_ror:2 row_mask:0xf bank_mask:0xf
    s_nop 1
    v_add_f32_dpp v10, v10, v10 row_ror:1 row_mask:0xf bank_mask:0xf
    v_mul_f32 v9, 0x3b000000, v10
    v_cvt_pk_bf16_f32 v9, v8, v9
    v_lshlrev_b32 v8, 16, v9
    v_and_b32 v9, 0xffff0000, v9
    v_add_f32 v9, 0x3727c5ac, v9
    v_cvt_pk_bf16_f32 v9, v9, v9
    v_lshlrev_b32 v9, 16, v9
    v_sqrt_f32 v9, v9
    s_nop 0
    v_cvt_pk_bf16_f32 v9, v9, v9
    v_lshlrev_b32 v9, 16, v9
    v_rcp_f32 v9, v9
    v_lshlrev_b32 v13, 16, v13
    v_sub_f32 v13, v13, v8
    v_cvt_pk_bf16_f32 v13, v13, v13
    v_lshlrev_b32 v13, 16, v13
    v_mul_f32 v13, v13, v9
    v_cvt_pk_bf16_f32 v13, v13, v13
    v_lshlrev_b32 v13, 16, v13
    v_lshlrev_b32 v5, 7, v3
    v_lshl_add_u32 v5, v7, 2, v5
    v_add_u32 v10, 64, v5
    v_lshlrev_b32 v14, 6, v3
    v_and_b32 v8, 8, v7
    v_lshl_add_u32 v14, v8, 2, v14
    v_and_b32 v8, 2, v7
    v_lshl_add_u32 v14, v8, 3, v14
    v_and_b32 v8, 4, v7
    v_lshl_add_u32 v14, v8, 1, v14
    s_lshl_b32 s99, s98, 8
    s_add_u32 s32, s99, 0x1000
    s_add_u32 s32, s30, s32
    s_addc_u32 s33, s31, 0
    v_mov_b32 v9, s28
    s_barrier
    ds_read2st64_b32 v[80:81], v5 offset0:0 offset1:2
    ds_read2st64_b32 v[82:83], v5 offset0:4 offset1:6
    ds_read2st64_b32 v[84:85], v10 offset0:0 offset1:2
    ds_read2st64_b32 v[86:87], v10 offset0:4 offset1:6
    s_waitcnt lgkmcnt(0)
    v_pk_add_f32 v[80:81], v[80:81], v[82:83]
    v_pk_add_f32 v[84:85], v[84:85], v[86:87]
    v_add_f32 v80, v80, v81
    v_add_f32 v81, v84, v85
    v_cvt_pk_bf16_f32 v81, v80, v81
    v_lshlrev_b32 v80, 16, v81
    v_and_b32 v81, 0xffff0000, v81
    v_add_f32 v81, 1.0, v81
    v_cvt_pk_bf16_f32 v81, v81, v81
    v_lshlrev_b32 v81, 16, v81
    v_mul_f32 v81, v13, v81
    v_cvt_pk_bf16_f32 v81, v81, v81
    v_lshlrev_b32 v81, 16, v81
    v_add_f32 v80, v81, v80
    s_nop 1
    v_mov_b32_dpp v81, v80 quad_perm:[1,1,3,3] row_mask:0xf bank_mask:0xf
    v_cvt_pk_bf16_f32 v8, v80, v81
    s_mov_b32 exec_lo, 0x55555555
    s_mov_b32 exec_hi, 0x55555555
    global_store_dwordx2 v14, v[8:9], s[32:33] sc1
    s_mov_b64 exec, -1
    s_branch L_DOWN
L_GQA3:
    s_barrier
    s_branch L_DOWN
.p2align 8
.fill (4096-768-(.-L_code0))/4, 4, 0xbf810000
.p2align 8
.type adaLN_cond__sliding_block_cached__swiglu_ffn__decode_kernel,@function
adaLN_cond__sliding_block_cached__swiglu_ffn__decode_kernel:
    s_load_dwordx16 s[4:19], s[0:1], 0
    s_load_dwordx8 s[20:27], s[0:1], 64
    s_load_dwordx2 s[30:31], s[0:1], 104
    s_cmp_ge_u32 s2, 256
    s_cbranch_scc1 L_exit
    v_lshrrev_b32 v1, 6, v0
    s_getpc_b64 s[46:47]
L_pc0:
    v_lshlrev_b32 v2, 7, v0
    v_readfirstlane_b32 s3, v1
    s_sub_u32 s46, s46, L_pc0-L_code0
    s_subb_u32 s47, s47, 0
    v_cmp_gt_u32 vcc, (L_exit-L_code0)/128, v0
    s_and_b32 s33, s2, 0xf8
    s_cmp_lg_u32 s33, 0x78
    s_cbranch_scc1 L_nopf
    s_cbranch_vccz L_nopf
    s_mov_b64 exec, vcc
    global_load_dword v127, v2, s[46:47]
    s_mov_b64 exec, -1
L_nopf:
    v_and_b32 v0, 63, v0
    s_and_b32 s40, s2, 7
    s_lshr_b32 s41, s2, 3
    v_lshrrev_b32 v1, 2, v0
    v_and_b32 v2, 3, v0
    v_lshrrev_b32 v3, 4, v0
    v_mov_b32 v4, 0
    v_and_b32 v5, 3, v1
    v_lshrrev_b32 v14, 3, v0
    v_and_b32 v15, 7, v0
    s_cmp_lg_u32 s3, 0
    s_cbranch_scc1 L_nopfa
    s_setprio 3
    v_lshl_add_u32 v6, s41, 4, v1
    v_mul_u32_u24 v6, 6144, v6
    v_and_b32 v7, 2, v0
    v_lshl_add_u32 v6, v7, 9, v6
    v_and_b32 v7, 1, v0
    v_lshl_add_u32 v6, v7, 6, v6
    v_lshl_add_u32 v6, s40, 7, v6
    s_waitcnt lgkmcnt(0)
    global_load_dword v127, v6, s[24:25]
    s_setprio 0
L_nopfa:
    s_cmp_lt_u32 s2, 128
    s_cbranch_scc1 L_G
    s_setprio 3
    s_sub_u32 s41, s41, 16
    s_cmp_ge_u32 s3, 1
    s_cbranch_scc1 L_nopfq
    s_lshl4_add_u32 s99, s3, s41
    s_add_u32 s99, s99, 48
    s_lshl_b32 s99, s99, 6
    s_add_u32 s99, s99, s40
    s_lshl_b32 s99, s99, 10
    v_lshlrev_b32 v8, 13, v14
    v_lshl_add_u32 v8, v15, 7, v8
    v_add_u32 v8, s99, v8
    s_waitcnt lgkmcnt(0)
    global_load_dword v127, v8, s[10:11]
L_nopfq:
    s_and_b32 s99, s41, 12
    s_lshl_b32 s99, s99, 1
    s_add_u32 s99, s99, s40
    s_lshl_b32 s99, s99, 4
    s_and_b32 s42, s41, 3
    s_add_u32 s99, s99, s42
    s_lshl_b32 s99, s99, 3
    s_add_u32 s99, s99, s3
    s_lshl_b32 s99, s99, 13
    s_add_u32 s99, s99, 786432
    v_and_b32 v8, 15, v0
    v_lshlrev_b32 v9, 2, v3
    v_xor_b32 v9, v9, v8
    v_lshlrev_b32 v9, 4, v9
    v_lshl_add_u32 v16, v3, 8, v9
    v_xor_b32 v17, 16, v16
    v_xor_b32 v18, 32, v16
    v_xor_b32 v19, 48, v16
    s_lshl_b32 s42, s3, 13
    s_add_u32 m0, s42, 28672
    s_waitcnt lgkmcnt(0)
    s_add_u32 s32, s6, s99
    s_addc_u32 s33, s7, 0
    s_add_u32 s34, s8, s99
    s_addc_u32 s35, s9, 0
    s_barrier
    global_load_dword v12, v4, s[30:31] sc1
    global_load_lds_dwordx4 v16, s[32:33] offset:0 nt
    global_load_lds_dwordx4 v17, s[32:33] offset:1024 nt
    global_load_lds_dwordx4 v18, s[32:33] offset:2048 nt
    global_load_lds_dwordx4 v19, s[32:33] offset:3072 nt
    s_add_u32 m0, m0, 4096
    s_add_u32 s32, s32, 4096
    s_addc_u32 s33, s33, 0
    global_load_lds_dwordx4 v16, s[32:33] offset:0 nt
    global_load_lds_dwordx4 v17, s[32:33] offset:1024 nt
    global_load_lds_dwordx4 v18, s[32:33] offset:2048 nt
    global_load_lds_dwordx4 v19, s[32:33] offset:3072 nt
    s_setprio 0
    s_branch L_A2
L_G:
    s_and_b32 s42, s41, 1
    s_lshr_b32 s99, s41, 2
    s_and_b32 s99, s99, 2
    s_or_b32 s44, s42, s99
    s_bfe_u32 s99, s41, 0x20001
    s_lshl2_add_u32 s98, s40, s99
    s_cmp_eq_u32 s44, 1
    s_cbranch_scc1 L_GA
    s_cmp_eq_u32 s44, 3
    s_cbranch_scc1 L_GB
    s_sub_u32 s43, s3, 1
    s_lshr_b32 s99, s41, 1
    s_lshl3_add_u32 s99, s43, s99
    s_cmp_ge_u32 s43, 6
    s_cbranch_scc1 L_nopfw
    s_lshl_b32 s99, s99, 6
    s_add_u32 s99, s99, s40
    s_lshl_b32 s99, s99, 10
    v_lshlrev_b32 v8, 13, v14
    v_lshl_add_u32 v8, v15, 7, v8
    v_add_u32 v8, s99, v8
    s_waitcnt lgkmcnt(0)
    global_load_dword v127, v8, s[10:11]
L_nopfw:
    s_cmp_eq_u32 s44, 3
    s_cbranch_scc1 L_GB
    s_lshl_b32 s99, s3, 9
    s_add_u32 s99, s99, s40
    s_lshl4_add_u32 s99, s99, s41
    s_lshl_b32 s99, s99, 6
    v_lshlrev_b32 v6, 16, v14
    v_lshl_add_u32 v6, v15, 4, v6
    s_movk_i32 s42, 8192
    s_lshr_b32 s43, s41, 2
    s_lshl2_add_u32 s43, s40, s43
    s_mul_i32 s43, s43, 8192
    s_and_b32 s98, s41, 2
    s_add_u32 s98, s98, s3
    s_lshl2_add_u32 s43, s98, s43
    s_add_u32 s43, s43, 0x20000
    v_and_b32 v96, 63, v0
    v_lshl_add_u32 v96, v96, 7, s43
    s_waitcnt lgkmcnt(0)
    s_add_u32 s34, s10, s99
    s_addc_u32 s35, s11, 0
    global_load_dword v12, v4, s[30:31] sc1
    s_cmp_lg_u32 s3, 1
    s_cbranch_scc1 L_G_ld
    global_load_dword v127, v96, s[30:31] sc1
L_G_ld:
    global_load_dwordx4 v[16:19], v6, s[34:35] nt
    v_add_u32 v6, s42, v6
    global_load_dwordx4 v[20:23], v6, s[34:35] nt
    v_add_u32 v6, s42, v6
    global_load_dwordx4 v[24:27], v6, s[34:35] nt
    v_add_u32 v6, s42, v6
    global_load_dwordx4 v[28:31], v6, s[34:35] nt
    v_add_u32 v6, s42, v6
    global_load_dwordx4 v[32:35], v6, s[34:35] nt
    v_add_u32 v6, s42, v6
    global_load_dwordx4 v[36:39], v6, s[34:35] nt
    v_add_u32 v6, s42, v6
    global_load_dwordx4 v[40:43], v6, s[34:35] nt
    v_add_u32 v6, s42, v6
    global_load_dwordx4 v[44:47], v6, s[34:35] nt
    s_cmp_eq_u32 s44, 1
    s_cbranch_scc0 L_GQ2
    s_branch L_GM2
L_GA:
    s_cmp_ge_u32 s3, 4
    s_cbranch_scc1 L_GQA
    s_lshl_b32 s99, s98, 5
    s_mul_i32 s42, s3, 786432
    s_add_u32 s99, s99, s42
    v_lshlrev_b32 v5, 10, v5
    v_lshl_add_u32 v5, v3, 6, v5
    v_lshl_add_u32 v5, v2, 4, v5
    v_lshl_add_u32 v5, s3, 8, v5
    v_mul_u32_u24 v6, 49152, v1
    v_and_b32 v7, 1, v2
    v_lshl_add_u32 v6, v7, 4, v6
    v_lshrrev_b32 v7, 1, v2
    v_lshl_add_u32 v6, v7, 10, v6
    v_mov_b32 v96, 0
    s_movk_i32 s42, 6144
    s_waitcnt lgkmcnt(0)
    s_add_u32 s34, s24, s99
    s_addc_u32 s35, s25, 0
    global_load_dwordx4 v[8:11], v5, s[22:23]
    s_barrier
    s_branch L_G_ld
L_GQA:
    s_setprio 3
    v_and_b32 v7, 15, v0
    v_lshlrev_b32 v13, 10, v3
    v_lshl_add_u32 v14, v7, 4, v13
    v_lshl_add_u32 v15, v7, 1, v13
    v_lshl_add_u32 v15, s98, 5, v15
    s_waitcnt lgkmcnt(0)
    s_cmp_lg_u32 s3, 7
    s_cbranch_scc1 L_GQA1
    global_load_dword v12, v4, s[30:31] sc1
    global_load_dwordx4 v[80:83], v14, s[4:5] offset:0
    global_load_dwordx4 v[84:87], v14, s[4:5] offset:256
    global_load_dwordx4 v[88:91], v14, s[4:5] offset:512
    global_load_dwordx4 v[92:95], v14, s[4:5] offset:768
    global_load_ushort v13, v15, s[4:5]
L_GQA1:
    s_barrier
    s_branch L_GQA2
L_GB:
    s_cmp_lg_u32 s3, 7
    s_cbranch_scc1 L_GB0
    s_setprio 3
    s_mul_i32 s99, s98, 7168
    s_add_u32 s99, s99, 0x61000
    v_lshlrev_b32 v6, 4, v0
    v_mov_b32 v8, -1
    v_mov_b32 v9, -1
    v_mov_b32 v10, -1
    v_mov_b32 v11, -1
    s_waitcnt lgkmcnt(0)
    s_add_u32 s32, s30, s99
    s_addc_u32 s33, s31, 0
    global_load_dword v12, v4, s[30:31] sc1
    global_store_dwordx4 v6, v[8:11], s[32:33] offset:-4096 sc1
    global_store_dwordx4 v6, v[8:11], s[32:33] offset:-3072 sc1
    global_store_dwordx4 v6, v[8:11], s[32:33] offset:-2048 sc1
    global_store_dwordx4 v6, v[8:11], s[32:33] offset:-1024 sc1
    global_store_dwordx4 v6, v[8:11], s[32:33] offset:0 sc1
    global_store_dwordx4 v6, v[8:11], s[32:33] offset:1024 sc1
    global_store_dwordx4 v6, v[8:11], s[32:33] offset:2048 sc1
L_GB0:
    s_and_b32 s99, s98, 3
    s_lshl2_add_u32 s99, s3, s99
    v_lshl_add_u32 v17, s99, 4, v1
    v_mul_u32_u24 v17, 6144, v17
    v_lshl_add_u32 v17, v2, 7, v17
    v_lshl_add_u32 v17, s40, 9, v17
    v_add_u32 v17, 0x800, v17
    s_cmp_ge_u32 s3, 3
    s_waitcnt lgkmcnt(0)
    s_barrier
    s_cbranch_scc1 L_GB2
    global_load_dword v127, v17, s[24:25]
    s_branch L_GB2
L_GM2:
    s_mov_b32 s14, s40
    s_mov_b32 s15, s41
    s_mov_b32 s96, 0x05040100
    s_mov_b32 s97, 0x07060302
    s_waitcnt vmcnt(8)
    v_lshlrev_b32 v80, 16, v8
    v_and_b32 v81, 0xffff0000, v8
    v_lshlrev_b32 v82, 16, v9
    v_and_b32 v83, 0xffff0000, v9
    v_lshlrev_b32 v84, 16, v10
    v_and_b32 v85, 0xffff0000, v10
    v_lshlrev_b32 v86, 16, v11
    v_and_b32 v87, 0xffff0000, v11
    v_mul_f32 v88, 0xbfb8aa3b, v80
    v_mul_f32 v89, 0xbfb8aa3b, v81
    v_mul_f32 v90, 0xbfb8aa3b, v82
    v_mul_f32 v91, 0xbfb8aa3b, v83
    v_mul_f32 v92, 0xbfb8aa3b, v84
    v_mul_f32 v93, 0xbfb8aa3b, v85
    v_mul_f32 v94, 0xbfb8aa3b, v86
    v_mul_f32 v95, 0xbfb8aa3b, v87
    v_exp_f32 v88, v88
    v_exp_f32 v89, v89
    v_exp_f32 v90, v90
    v_exp_f32 v91, v91
    v_exp_f32 v92, v92
    v_exp_f32 v93, v93
    v_exp_f32 v94, v94
    v_exp_f32 v95, v95
    v_add_f32 v88, 1.0, v88
    v_add_f32 v89, 1.0, v89
    v_add_f32 v90, 1.0, v90
    v_add_f32 v91, 1.0, v91
    v_add_f32 v92, 1.0, v92
    v_add_f32 v93, 1.0, v93
    v_add_f32 v94, 1.0, v94
    v_add_f32 v95, 1.0, v95
    v_rcp_f32 v88, v88
    v_rcp_f32 v89, v89
    v_rcp_f32 v90, v90
    v_rcp_f32 v91, v91
    v_rcp_f32 v92, v92
    v_rcp_f32 v93, v93
    v_rcp_f32 v94, v94
    v_rcp_f32 v95, v95
    v_mul_f32 v80, v80, v88
    v_mul_f32 v81, v81, v89
    v_mul_f32 v82, v82, v90
    v_mul_f32 v83, v83, v91
    v_mul_f32 v84, v84, v92
    v_mul_f32 v85, v85, v93
    v_mul_f32 v86, v86, v94
    v_mul_f32 v87, v87, v95
    v_cvt_pk_bf16_f32 v8, v80, v81
    v_cvt_pk_bf16_f32 v9, v82, v83
    v_cvt_pk_bf16_f32 v10, v84, v85
    v_cvt_pk_bf16_f32 v11, v86, v87
    v_lshlrev_b32 v5, 7, v3
    v_lshl_add_u32 v5, v2, 5, v5
    v_lshl_add_u32 v5, s3, 9, v5
    s_waitcnt vmcnt(6)
    v_perm_b32 v48, v20, v16, s96
    v_perm_b32 v52, v20, v16, s97
    v_perm_b32 v56, v21, v17, s96
    v_perm_b32 v60, v21, v17, s97
    v_perm_b32 v64, v22, v18, s96
    v_perm_b32 v68, v22, v18, s97
    v_perm_b32 v72, v23, v19, s96
    v_perm_b32 v76, v23, v19, s97
    s_waitcnt vmcnt(4)
    v_perm_b32 v49, v28, v24, s96
    v_perm_b32 v53, v28, v24, s97
    v_perm_b32 v57, v29, v25, s96
    v_perm_b32 v61, v29, v25, s97
    v_perm_b32 v65, v30, v26, s96
    v_perm_b32 v69, v30, v26, s97
    v_perm_b32 v73, v31, v27, s96
    v_perm_b32 v77, v31, v27, s97
    s_waitcnt vmcnt(2)
    v_perm_b32 v50, v36, v32, s96
    v_perm_b32 v54, v36, v32, s97
    v_perm_b32 v58, v37, v33, s96
    v_perm_b32 v62, v37, v33, s97
    v_perm_b32 v66, v38, v34, s96
    v_perm_b32 v70, v38, v34, s97
    v_perm_b32 v74, v39, v35, s96
    v_perm_b32 v78, v39, v35, s97
    s_waitcnt vmcnt(0)
    v_perm_b32 v51, v44, v40, s96
    v_perm_b32 v55, v44, v40, s97
    v_perm_b32 v59, v45, v41, s96
    v_perm_b32 v63, v45, v41, s97
    v_perm_b32 v67, v46, v42, s96
    v_perm_b32 v71, v46, v42, s97
    v_perm_b32 v75, v47, v43, s96
    v_perm_b32 v79, v47, v43, s97
    v_mfma_f32_16x16x32_bf16 v[16:19], v[8:11], v[48:51], 0
    v_mfma_f32_16x16x32_bf16 v[20:23], v[8:11], v[52:55], 0
    v_mfma_f32_16x16x32_bf16 v[24:27], v[8:11], v[56:59], 0
    v_mfma_f32_16x16x32_bf16 v[28:31], v[8:11], v[60:63], 0
    v_mfma_f32_16x16x32_bf16 v[32:35], v[8:11], v[64:67], 0
    v_mfma_f32_16x16x32_bf16 v[36:39], v[8:11], v[68:71], 0
    v_mfma_f32_16x16x32_bf16 v[40:43], v[8:11], v[72:75], 0
    v_mfma_f32_16x16x32_bf16 v[44:47], v[8:11], v[76:79], 0
    s_nop 0
    v_add_f32_dpp v48, v17, v16 row_shl:4 row_mask:0xf bank_mask:0xf
    v_add_f32_dpp v49, v21, v20 row_shl:4 row_mask:0xf bank_mask:0xf
    v_add_f32_dpp v50, v25, v24 row_shl:4 row_mask:0xf bank_mask:0xf
    v_add_f32_dpp v51, v29, v28 row_shl:4 row_mask:0xf bank_mask:0xf
    v_add_f32_dpp v52, v33, v32 row_shl:4 row_mask:0xf bank_mask:0xf
    v_add_f32_dpp v53, v37, v36 row_shl:4 row_mask:0xf bank_mask:0xf
    v_add_f32_dpp v54, v41, v40 row_shl:4 row_mask:0xf bank_mask:0xf
    v_add_f32_dpp v55, v45, v44 row_shl:4 row_mask:0xf bank_mask:0xf
    v_add_f32_dpp v48, v18, v48 row_shl:8 row_mask:0xf bank_mask:0xf
    v_add_f32_dpp v49, v22, v49 row_shl:8 row_mask:0xf bank_mask:0xf
    v_add_f32_dpp v50, v26, v50 row_shl:8 row_mask:0xf bank_mask:0xf
    v_add_f32_dpp v51, v30, v51 row_shl:8 row_mask:0xf bank_mask:0xf
    v_add_f32_dpp v52, v34, v52 row_shl:8 row_mask:0xf bank_mask:0xf
    v_add_f32_dpp v53, v38, v53 row_shl:8 row_mask:0xf bank_mask:0xf
    v_add_f32_dpp v54, v42, v54 row_shl:8 row_mask:0xf bank_mask:0xf
    v_add_f32_dpp v55, v46, v55 row_shl:8 row_mask:0xf bank_mask:0xf
    v_add_f32_dpp v48, v19, v48 row_shl:12 row_mask:0xf bank_mask:0xf
    v_add_f32_dpp v49, v23, v49 row_shl:12 row_mask:0xf bank_mask:0xf
    v_add_f32_dpp v50, v27, v50 row_shl:12 row_mask:0xf bank_mask:0xf
    v_add_f32_dpp v51, v31, v51 row_shl:12 row_mask:0xf bank_mask:0xf
    v_add_f32_dpp v52, v35, v52 row_shl:12 row_mask:0xf bank_mask:0xf
    v_add_f32_dpp v53, v39, v53 row_shl:12 row_mask:0xf bank_mask:0xf
    v_add_f32_dpp v54, v43, v54 row_shl:12 row_mask:0xf bank_mask:0xf
    v_add_f32_dpp v55, v47, v55 row_shl:12 row_mask:0xf bank_mask:0xf
    s_mov_b32 exec_lo, 0xf000f
    s_mov_b32 exec_hi, 0xf000f
    ds_write_b128 v5, v[48:51]
    ds_write_b128 v5, v[52:55] offset:16
    s_mov_b64 exec, -1
    s_waitcnt lgkmcnt(0)
    s_barrier
    s_branch L_DOWN
L_GQ2:
    s_mov_b32 s14, s40
    s_mov_b32 s15, s41
    s_mov_b32 s96, 0x05040100
    s_mov_b32 s97, 0x07060302
    s_lshl_b32 s99, s3, 10
    s_add_u32 s32, s99, 0x1000
    s_add_u32 s32, s30, s32
    s_addc_u32 s33, s31, 0
    s_lshl_b32 s99, s3, 9
    s_add_u32 s36, s99, 0x3000
    s_add_u32 s36, s30, s36
    s_addc_u32 s37, s31, 0
    v_lshlrev_b32 v5, 6, v1
    v_and_b32 v7, 1, v0
    v_lshl_add_u32 v5, v7, 5, v5
    v_lshlrev_b32 v98, 7, v2
    v_lshlrev_b32 v6, 8, v3
    v_lshl_add_u32 v6, v15, 5, v6
    v_lshl_add_u32 v6, s3, 10, v6
    v_lshlrev_b32 v7, 3, v0
    v_lshl_add_u32 v7, s3, 9, v7
    s_lshl_b32 s99, s14, 12
    s_lshl_b32 s40, s15, 6
    s_add_u32 s99, s99, s40
    s_and_b32 s40, s3, 1
    s_lshl_b32 s40, s40, 11
    s_add_u32 s99, s99, s40
    v_and_b32 v97, 31, v0
    v_lshl_add_u32 v97, v97, 2, s99
    v_and_b32 v99, 32, v0
    v_lshl_add_u32 v97, v99, 5, v97
    v_lshlrev_b32 v99, 1, v97
    s_add_u32 s34, s30, 0x4000
    s_addc_u32 s35, s31, 0
L_GQ3:
    s_waitcnt vmcnt(8)
    v_readfirstlane_b32 s28, v12
    s_nop 1
    s_mul_i32 s28, s28, 1664525
    s_add_u32 s28, s28, 1013904223
    s_getreg_b32 s99, hwreg(HW_REG_XCC_ID, 0, 4)
    s_xor_b32 s99, s28, s99
    v_mov_b32 v101, s99
    s_barrier
    global_load_dwordx4 v[8:11], v5, s[32:33] sc1
    global_load_dwordx4 v[12:15], v5, s[32:33] offset:16 sc1
    global_load_dword v84, v98, s[36:37] sc1
    s_waitcnt vmcnt(9)
    v_perm_b32 v48, v20, v16, s96
    v_perm_b32 v52, v20, v16, s97
    v_perm_b32 v56, v21, v17, s96
    v_perm_b32 v60, v21, v17, s97
    v_perm_b32 v64, v22, v18, s96
    v_perm_b32 v68, v22, v18, s97
    v_perm_b32 v72, v23, v19, s96
    v_perm_b32 v76, v23, v19, s97
    s_waitcnt vmcnt(7)
    v_perm_b32 v49, v28, v24, s96
    v_perm_b32 v53, v28, v24, s97
    v_perm_b32 v57, v29, v25, s96
    v_perm_b32 v61, v29, v25, s97
    v_perm_b32 v65, v30, v26, s96
    v_perm_b32 v69, v30, v26, s97
    v_perm_b32 v73, v31, v27, s96
    v_perm_b32 v77, v31, v27, s97
    s_waitcnt vmcnt(5)
    v_perm_b32 v50, v36, v32, s96
    v_perm_b32 v54, v36, v32, s97
    v_perm_b32 v58, v37, v33, s96
    v_perm_b32 v62, v37, v33, s97
    v_perm_b32 v66, v38, v34, s96
    v_perm_b32 v70, v38, v34, s97
    v_perm_b32 v74, v39, v35, s96
    v_perm_b32 v78, v39, v35, s97
    s_waitcnt vmcnt(3)
    v_perm_b32 v51, v44, v40, s96
    v_perm_b32 v55, v44, v40, s97
    v_perm_b32 v59, v45, v41, s96
    v_perm_b32 v63, v45, v41, s97
    v_perm_b32 v67, v46, v42, s96
    v_perm_b32 v71, v46, v42, s97
    v_perm_b32 v75, v47, v43, s96
    v_perm_b32 v79, v47, v43, s97
    s_mov_b32 s98, 100000
    s_branch L_GQ6
L_poll3:
    global_load_dwordx4 v[8:11], v5, s[32:33] sc1
    global_load_dwordx4 v[12:15], v5, s[32:33] offset:16 sc1
    global_load_dword v84, v98, s[36:37] sc1
L_GQ6:
    s_sub_u32 s98, s98, 1
    s_cselect_b64 s[38:39], 0, -1
    s_waitcnt vmcnt(0)
L_GQ8:
    v_xor_b32 v80, s28, v9
    v_xor_b32 v81, s28, v11
    v_mov_b32 v9, v12
    v_mov_b32 v11, v14
    v_xor_b32 v82, s28, v13
    v_xor_b32 v83, s28, v15
    v_mfma_f32_16x16x32_bf16 v[16:19], v[8:11], v[48:51], 0
    v_xor_b32 v84, s28, v84
    v_or3_b32 v80, v80, v81, v82
    v_mfma_f32_16x16x32_bf16 v[20:23], v[8:11], v[52:55], 0
    v_or3_b32 v80, v80, v83, v84
    v_cmp_ne_u32 vcc, 0, v80
    s_and_b64 vcc, vcc, s[38:39]
    s_cbranch_scc1 L_poll3
    v_mfma_f32_16x16x32_bf16 v[24:27], v[8:11], v[56:59], 0
    v_mfma_f32_16x16x32_bf16 v[28:31], v[8:11], v[60:63], 0
    v_mfma_f32_16x16x32_bf16 v[32:35], v[8:11], v[64:67], 0
    v_mfma_f32_16x16x32_bf16 v[36:39], v[8:11], v[68:71], 0
    v_mfma_f32_16x16x32_bf16 v[40:43], v[8:11], v[72:75], 0
    v_mfma_f32_16x16x32_bf16 v[44:47], v[8:11], v[76:79], 0
    v_add_f32_dpp v80, v17, v16 row_shl:8 row_mask:0xf bank_mask:0xf
    v_add_f32_dpp v81, v21, v20 row_shl:8 row_mask:0xf bank_mask:0xf
    s_nop 0
    v_add_f32_dpp v82, v25, v24 row_shl:8 row_mask:0xf bank_mask:0xf
    v_add_f32_dpp v83, v29, v28 row_shl:8 row_mask:0xf bank_mask:0xf
    v_add_f32_dpp v84, v33, v32 row_shl:8 row_mask:0xf bank_mask:0xf
    v_add_f32_dpp v85, v37, v36 row_shl:8 row_mask:0xf bank_mask:0xf
    v_add_f32_dpp v86, v41, v40 row_shl:8 row_mask:0xf bank_mask:0xf
    v_add_f32_dpp v87, v45, v44 row_shl:8 row_mask:0xf bank_mask:0xf
    s_mov_b32 exec_lo, 0xff00ff
    s_mov_b32 exec_hi, 0xff00ff
    ds_write_b128 v6, v[80:83]
    ds_write_b128 v6, v[84:87] offset:16
    s_mov_b64 exec, -1
    s_waitcnt lgkmcnt(0)
    s_cmp_ge_u32 s3, 2
    s_barrier
    s_cbranch_scc1 L_GQ5
    ds_read2st64_b64 v[16:19], v7 offset0:0 offset1:2
    ds_read2st64_b64 v[20:23], v7 offset0:4 offset1:6
    ds_read2st64_b64 v[24:27], v7 offset0:8 offset1:10
    ds_read2st64_b64 v[28:31], v7 offset0:12 offset1:14
    s_add_u32 s32, s30, 0x10000
    s_addc_u32 s33, s31, 0
    s_waitcnt lgkmcnt(2)
    v_pk_add_f32 v[16:17], v[16:17], v[18:19]
    v_pk_add_f32 v[20:21], v[20:21], v[22:23]
    s_waitcnt lgkmcnt(1)
    v_pk_add_f32 v[24:25], v[24:25], v[26:27]
    v_pk_add_f32 v[16:17], v[16:17], v[20:21]
    s_waitcnt lgkmcnt(0)
    v_pk_add_f32 v[28:29], v[28:29], v[30:31]
    v_pk_add_f32 v[16:17], v[16:17], v[24:25]
    v_pk_add_f32 v[16:17], v[16:17], v[28:29]
    v_cvt_pk_bf16_f32 v100, v16, v17
    global_store_dword v97, v100, s[34:35]
    s_waitcnt vmcnt(0)
    global_store_dword v96, v101, s[30:31]
    global_store_dwordx2 v99, v[100:101], s[32:33] sc1
    s_branch L_WO
L_GQ5:
    s_branch L_WO
L_GB1:
    s_waitcnt lgkmcnt(0)
L_GB2:
    s_mov_b32 s14, s40
    s_mov_b32 s15, s41
    s_mov_b32 s96, 0x05040100
    s_mov_b32 s97, 0x07060302
    s_lshl3_add_u32 s99, s15, s3
    s_cmp_lg_u32 s99, 93
    s_cbranch_scc1 L_GBq
    s_lshl_b32 s99, s14, 12
    s_add_u32 s32, s99, 0x4000
    s_add_u32 s32, s30, s32
    s_addc_u32 s33, s31, 0
    v_lshlrev_b32 v9, 6, v0
    global_load_dword v127, v9, s[32:33] sc1
L_GBq:
    v_lshlrev_b32 v5, 10, v5
    v_lshl_add_u32 v5, v3, 5, v5
    v_and_b32 v7, 1, v0
    v_lshl_add_u32 v5, v7, 4, v5
    v_lshl_add_u32 v16, s3, 7, v5
    s_lshl_b32 s99, s98, 7
    s_mul_i32 s42, s3, 393216
    s_add_u32 s99, s99, s42
    s_add_u32 s36, s99, 0x800
    s_add_u32 s36, s24, s36
    s_addc_u32 s37, s25, 0
    s_lshl_b32 s43, s98, 9
    v_mul_u32_u24 v13, 49152, v14
    v_lshl_add_u32 v13, v15, 4, v13
    s_movk_i32 s42, 6144
    s_cmp_lg_u32 s3, 7
    s_cbranch_scc1 L_GB3
    s_waitcnt vmcnt(0)
    v_readfirstlane_b32 s28, v12
    s_nop 1
    s_mul_i32 s28, s28, 1664525
    s_add_u32 s28, s28, 1013904223
    s_add_u32 s34, s30, 0x3000
    s_addc_u32 s35, s31, 0
    v_lshlrev_b32_e64 v5, 7, s98
    v_mov_b32 v6, s28
    s_mov_b64 exec, 1
    global_store_dword v5, v6, s[34:35] sc1
    s_mov_b64 exec, -1
    s_setprio 0
L_GB3:
    s_barrier
    s_cmp_lt_u32 s3, 3
    s_cbranch_scc1 L_GBd
    global_load_dword v127, v17, s[24:25]
L_GBd:
    s_barrier
    global_load_dwordx4 v[8:11], v16, s[22:23]
    global_load_dwordx4 v[16:19], v13, s[36:37] nt
    v_add_u32 v13, s42, v13
    global_load_dwordx4 v[20:23], v13, s[36:37] nt
    v_add_u32 v13, s42, v13
    global_load_dwordx4 v[24:27], v13, s[36:37] nt
    v_add_u32 v13, s42, v13
    global_load_dwordx4 v[28:31], v13, s[36:37] nt
    v_add_u32 v13, s42, v13
    global_load_dwordx4 v[32:35], v13, s[36:37] nt
    v_add_u32 v13, s42, v13
    global_load_dwordx4 v[36:39], v13, s[36:37] nt
    v_add_u32 v13, s42, v13
    global_load_dwordx4 v[40:43], v13, s[36:37] nt
    v_add_u32 v13, s42, v13
    global_load_dwordx4 v[44:47], v13, s[36:37] nt
    s_waitcnt vmcnt(8)
    v_lshlrev_b32 v80, 16, v8
    v_and_b32 v81, 0xffff0000, v8
    v_lshlrev_b32 v82, 16, v9
    v_and_b32 v83, 0xffff0000, v9
    v_lshlrev_b32 v84, 16, v10
    v_and_b32 v85, 0xffff0000, v10
    v_lshlrev_b32 v86, 16, v11
    v_and_b32 v87, 0xffff0000, v11
    v_mul_f32 v88, 0xbfb8aa3b, v80
    v_mul_f32 v89, 0xbfb8aa3b, v81
    v_mul_f32 v90, 0xbfb8aa3b, v82
    v_mul_f32 v91, 0xbfb8aa3b, v83
    v_mul_f32 v92, 0xbfb8aa3b, v84
    v_mul_f32 v93, 0xbfb8aa3b, v85
    v_mul_f32 v94, 0xbfb8aa3b, v86
    v_mul_f32 v95, 0xbfb8aa3b, v87
    v_exp_f32 v88, v88
    v_exp_f32 v89, v89
    v_exp_f32 v90, v90
    v_exp_f32 v91, v91
    v_exp_f32 v92, v92
    v_exp_f32 v93, v93
    v_exp_f32 v94, v94
    v_exp_f32 v95, v95
    v_add_f32 v88, 1.0, v88
    v_add_f32 v89, 1.0, v89
    v_add_f32 v90, 1.0, v90
    v_add_f32 v91, 1.0, v91
    v_add_f32 v92, 1.0, v92
    v_add_f32 v93, 1.0, v93
    v_add_f32 v94, 1.0, v94
    v_add_f32 v95, 1.0, v95
    v_rcp_f32 v88, v88
    v_rcp_f32 v89, v89
    v_rcp_f32 v90, v90
    v_rcp_f32 v91, v91
    v_rcp_f32 v92, v92
    v_rcp_f32 v93, v93
    v_rcp_f32 v94, v94
    v_rcp_f32 v95, v95
    v_mul_f32 v80, v80, v88
    v_mul_f32 v81, v81, v89
    v_mul_f32 v82, v82, v90
    v_mul_f32 v83, v83, v91
    v_mul_f32 v84, v84, v92
    v_mul_f32 v85, v85, v93
    v_mul_f32 v86, v86, v94
    v_mul_f32 v87, v87, v95
    v_cvt_pk_bf16_f32 v8, v80, v81
    v_cvt_pk_bf16_f32 v9, v82, v83
    v_cvt_pk_bf16_f32 v10, v84, v85
    v_cvt_pk_bf16_f32 v11, v86, v87
    v_lshlrev_b32 v6, 8, v3
    v_lshl_add_u32 v6, v15, 5, v6
    v_lshl_add_u32 v6, s3, 10, v6
    v_lshlrev_b32 v7, 3, v0
    v_lshl_add_u32 v7, s3, 9, v7
    s_waitcnt vmcnt(6)
    v_perm_b32 v48, v20, v16, s96
    v_perm_b32 v52, v20, v16, s97
    v_perm_b32 v56, v21, v17, s96
    v_perm_b32 v60, v21, v17, s97
    v_perm_b32 v64, v22, v18, s96
    v_perm_b32 v68, v22, v18, s97
    v_perm_b32 v72, v23, v19, s96
    v_perm_b32 v76, v23, v19, s97
    s_waitcnt vmcnt(4)
    v_perm_b32 v49, v28, v24, s96
    v_perm_b32 v53, v28, v24, s97
    v_perm_b32 v57, v29, v25, s96
    v_perm_b32 v61, v29, v25, s97
    v_perm_b32 v65, v30, v26, s96
    v_perm_b32 v69, v30, v26, s97
    v_perm_b32 v73, v31, v27, s96
    v_perm_b32 v77, v31, v27, s97
    s_waitcnt vmcnt(2)
    v_perm_b32 v50, v36, v32, s96
    v_perm_b32 v54, v36, v32, s97
    v_perm_b32 v58, v37, v33, s96
    v_perm_b32 v62, v37, v33, s97
    v_perm_b32 v66, v38, v34, s96
    v_perm_b32 v70, v38, v34, s97
    v_perm_b32 v74, v39, v35, s96
    v_perm_b32 v78, v39, v35, s97
    s_waitcnt vmcnt(0)
    v_perm_b32 v51, v44, v40, s96
    v_perm_b32 v55, v44, v40, s97
    v_perm_b32 v59, v45, v41, s96
    v_perm_b32 v63, v45, v41, s97
    v_perm_b32 v67, v46, v42, s96
    v_perm_b32 v71, v46, v42, s97
    v_perm_b32 v75, v47, v43, s96
    v_perm_b32 v79, v47, v43, s97
    v_mfma_f32_16x16x32_bf16 v[16:19], v[8:11], v[48:51], 0
    v_mfma_f32_16x16x32_bf16 v[20:23], v[8:11], v[52:55], 0
    v_mfma_f32_16x16x32_bf16 v[24:27], v[8:11], v[56:59], 0
    v_mfma_f32_16x16x32_bf16 v[28:31], v[8:11], v[60:63], 0
    v_mfma_f32_16x16x32_bf16 v[32:35], v[8:11], v[64:67], 0
    v_mfma_f32_16x16x32_bf16 v[36:39], v[8:11], v[68:71], 0
    v_mfma_f32_16x16x32_bf16 v[40:43], v[8:11], v[72:75], 0
    v_mfma_f32_16x16x32_bf16 v[44:47], v[8:11], v[76:79], 0
    s_nop 0
    v_add_f32_dpp v80, v17, v16 row_shl:8 row_mask:0xf bank_mask:0xf
    v_add_f32_dpp v81, v21, v20 row_shl:8 row_mask:0xf bank_mask:0xf
    v_add_f32_dpp v82, v25, v24 row_shl:8 row_mask:0xf bank_mask:0xf
    v_add_f32_dpp v83, v29, v28 row_shl:8 row_mask:0xf bank_mask:0xf
    v_add_f32_dpp v84, v33, v32 row_shl:8 row_mask:0xf bank_mask:0xf
    v_add_f32_dpp v85, v37, v36 row_shl:8 row_mask:0xf bank_mask:0xf
    v_add_f32_dpp v86, v41, v40 row_shl:8 row_mask:0xf bank_mask:0xf
    v_add_f32_dpp v87, v45, v44 row_shl:8 row_mask:0xf bank_mask:0xf
    s_mov_b32 exec_lo, 0xff00ff
    s_mov_b32 exec_hi, 0xff00ff
    ds_write_b128 v6, v[80:83]
    ds_write_b128 v6, v[84:87] offset:16
    s_mov_b64 exec, -1
    s_cmp_lg_u32 s3, 7
    s_cbranch_scc1 L_GB4
    s_add_u32 s34, s30, 0x3000
    s_addc_u32 s35, s31, 0
    v_and_b32 v5, 31, v0
    v_lshlrev_b32 v5, 7, v5
    s_mov_b32 s98, 100000
L_poll4:
    global_load_dword v6, v5, s[34:35] sc1
    s_sleep 4
    s_sub_u32 s98, s98, 1
    s_cselect_b64 s[38:39], 0, -1
    s_waitcnt vmcnt(0)
    v_cmp_ne_u32 vcc, s28, v6
    s_and_b64 vcc, vcc, s[38:39]
    s_cbranch_scc1 L_poll4
L_GB4:
    s_waitcnt lgkmcnt(0)
    s_barrier
    s_cmp_ge_u32 s3, 2
    s_cbranch_scc1 L_HB
    ds_read2st64_b64 v[16:19], v7 offset0:0 offset1:2
    ds_read2st64_b64 v[20:23], v7 offset0:4 offset1:6
    ds_read2st64_b64 v[24:27], v7 offset0:8 offset1:10
    ds_read2st64_b64 v[28:31], v7 offset0:12 offset1:14
    s_add_u32 s32, s43, 0x60000
    s_add_u32 s32, s30, s32
    s_addc_u32 s33, s31, 0
    v_and_b32 v5, 2, v0
    v_lshlrev_b32 v5, 7, v5
    v_and_b32 v6, 32, v0
    v_lshl_add_u32 v5, v6, 1, v5
    v_lshl_add_u32 v5, s3, 7, v5
    v_and_b32 v6, 13, v0
    v_lshl_add_u32 v5, v6, 2, v5
    v_bfe_u32 v6, v0, 4, 1
    v_lshl_add_u32 v5, v6, 3, v5
    s_waitcnt lgkmcnt(2)
    v_pk_add_f32 v[16:17], v[16:17], v[18:19]
    v_pk_add_f32 v[20:21], v[20:21], v[22:23]
    s_waitcnt lgkmcnt(1)
    v_pk_add_f32 v[24:25], v[24:25], v[26:27]
    v_pk_add_f32 v[16:17], v[16:17], v[20:21]
    s_waitcnt lgkmcnt(0)
    v_pk_add_f32 v[28:29], v[28:29], v[30:31]
    v_pk_add_f32 v[16:17], v[16:17], v[24:25]
    v_pk_add_f32 v[16:17], v[16:17], v[28:29]
    v_cvt_pk_bf16_f32 v12, v16, v17
    global_store_dword v5, v12, s[32:33] sc1
    s_branch L_HB
L_HB:
    s_barrier
    s_bfe_u32 s41, s15, 0x20001
    s_bfe_u32 s41, s15, 0x20001
    s_sub_u32 s41, 3, s41
    s_lshl3_add_u32 s41, s41, s3
    s_cmp_ge_u32 s41, 16
    s_cbranch_scc1 L_gh5
    s_bitcmp0_b32 s41, 4
    s_cselect_b64 s[32:33], s[18:19], s[16:17]
    s_and_b32 s99, s41, 15
    s_lshl2_add_u32 s99, s99, 2
    s_mul_i32 s99, s99, 28672
    s_mul_i32 s40, s14, 448
    s_andn2_b32 s40, s40, 127
    s_add_u32 s99, s99, s40
    v_mul_u32_u24 v13, 3584, v1
    v_lshl_add_u32 v13, v2, 7, v13
    v_add_u32 v13, s99, v13
    global_load_dword v127, v13, s[32:33]
L_gh5:
    s_bfe_u32 s41, s15, 0x20001
    s_cmp_eq_u32 s41, 0
    s_cbranch_scc1 L_HBd
    s_mul_i32 s99, s3, 3
    s_add_u32 s99, s99, s41
    s_add_u32 s99, s99, 7
    s_cmp_ge_u32 s99, 28
    s_cbranch_scc1 L_HBd
    s_lshl_b32 s99, s99, 9
    s_add_u32 s99, s99, s14
    s_lshl_b32 s99, s99, 7
    v_lshl_add_u32 v8, v0, 10, s99
    s_waitcnt vmcnt(0)
    global_load_dword v127, v8, s[20:21]
L_HBd:
    s_lshl3_add_u32 s99, s15, s3
    s_cmp_lg_u32 s99, 79
    s_cbranch_scc1 L_fin
    s_lshl_b32 s99, s14, 14
    s_add_u32 s32, s99, 0x73f00
    s_add_u32 s32, s30, s32
    s_addc_u32 s33, s31, 0
    v_and_b32 v5, 15, v0
    v_lshlrev_b32 v5, 4, v5
    v_lshl_add_u32 v5, v3, 12, v5
    s_lshl_b32 s99, s14, 7
    s_add_u32 s34, s99, 0x93000
    s_add_u32 s34, s30, s34
    s_addc_u32 s35, s31, 0
    s_movk_i32 s98, 100
L_HBg:
    global_load_dword v6, v5, s[32:33] sc1
    s_sub_u32 s98, s98, 1
    s_cselect_b64 s[38:39], 0, -1
    s_waitcnt vmcnt(0)
    v_cmp_eq_u32 vcc, -1, v6
    s_and_b64 vcc, vcc, s[38:39]
    s_cbranch_scc1 L_HBg
    s_mov_b64 exec, 1
    global_store_dword v4, v4, s[34:35] sc1
    s_endpgm
L_DOWN:
    s_setprio 0
    s_barrier
    s_lshr_b32 s41, s15, 1
    s_mul_i32 s99, s41, 14
    s_add_u32 s99, s99, s3
    s_lshl_b32 s43, s14, 6
    s_add_u32 s99, s99, s43
    s_add_u32 s99, s99, 0
    s_lshl_b32 s99, s99, 13
    v_lshl_add_u32 v8, v0, 7, s99
    global_load_dword v127, v8, s[12:13]
L_wp6:
    s_cmp_ge_u32 s3, 6
    s_cbranch_scc1 L_wp7
    s_mul_i32 s99, s41, 14
    s_add_u32 s99, s99, s3
    s_lshl_b32 s43, s14, 6
    s_add_u32 s99, s99, s43
    s_add_u32 s99, s99, 8
    s_lshl_b32 s99, s99, 13
    v_lshl_add_u32 v8, v0, 7, s99
    global_load_dword v127, v8, s[12:13]
L_wp7:
    s_cmp_lg_u32 s3, 7
    s_cbranch_scc1 L_DNw
    s_add_u32 s34, s30, 0x3000
    s_addc_u32 s35, s31, 0
    v_and_b32 v5, 31, v0
    v_lshlrev_b32 v5, 7, v5
    s_mov_b32 s98, 100000
L_poll8:
    global_load_dword v6, v5, s[34:35] sc1
    s_sleep 4
    s_sub_u32 s98, s98, 1
    s_cselect_b64 s[38:39], 0, -1
    s_waitcnt vmcnt(0)
    v_cmp_ne_u32 vcc, s28, v6
    s_and_b64 vcc, vcc, s[38:39]
    s_cbranch_scc1 L_poll8
    s_lshl_b32 s99, s14, 9
    s_add_u32 s32, s99, 0x72000
    s_add_u32 s32, s30, s32
    s_addc_u32 s33, s31, 0
    v_lshlrev_b32 v5, 3, v0
    s_movk_i32 s98, 60
L_DNg:
    global_load_dword v6, v5, s[32:33] sc1
    s_sleep 2
    s_sub_u32 s98, s98, 1
    s_cselect_b64 s[38:39], 0, -1
    s_waitcnt vmcnt(0)
    v_cmp_ne_u32 vcc, -1, v6
    s_cmp_eq_u64 vcc, 0
    s_cselect_b64 vcc, -1, 0
    s_and_b64 vcc, vcc, s[38:39]
    s_cbranch_scc1 L_DNg
L_DNw:
    s_barrier
    s_cmp_eq_u32 s3, 7
    s_cbranch_scc1 L_DN7
    s_lshl2_add_u32 s99, s3, s41
    s_lshl_b32 s99, s99, 9
    s_add_u32 s99, s99, s14
    s_lshl_b32 s99, s99, 7
    v_lshl_add_u32 v8, v0, 10, s99
    s_cmp_ge_u32 s3, 2
    s_cbranch_scc1 L_DNr
    s_waitcnt vmcnt(0)
    global_load_dword v127, v8, s[20:21]
L_DNr:
    s_waitcnt vmcnt(0)
    s_barrier
    s_waitcnt vmcnt(0)
    s_lshr_b32 s41, s15, 1
    s_lshl2_add_u32 s99, s14, s41
    s_lshl_b32 s99, s99, 5
    s_lshl_b32 s41, s3, 18
    s_add_u32 s99, s99, s41
    s_add_u32 s34, s99, 0x1000
    s_add_u32 s34, s20, s34
    s_addc_u32 s35, s21, 0
    v_lshlrev_b32 v6, 13, v1
    v_lshl_add_u32 v6, v2, 3, v6
    v_add_u32 v7, 0x20000, v6
    global_load_dwordx2 v[128:129], v6, s[34:35] offset:-4096
    global_load_dwordx2 v[130:131], v6, s[34:35] offset:-3072
    global_load_dwordx2 v[132:133], v6, s[34:35] offset:-2048
    global_load_dwordx2 v[134:135], v6, s[34:35] offset:-1024
    global_load_dwordx2 v[136:137], v6, s[34:35] offset:0
    global_load_dwordx2 v[138:139], v6, s[34:35] offset:1024
    global_load_dwordx2 v[140:141], v6, s[34:35] offset:2048
    global_load_dwordx2 v[142:143], v6, s[34:35] offset:3072
    global_load_dwordx2 v[144:145], v7, s[34:35] offset:-4096
    global_load_dwordx2 v[146:147], v7, s[34:35] offset:-3072
    global_load_dwordx2 v[148:149], v7, s[34:35] offset:-2048
    global_load_dwordx2 v[150:151], v7, s[34:35] offset:-1024
    global_load_dwordx2 v[152:153], v7, s[34:35] offset:0
    global_load_dwordx2 v[154:155], v7, s[34:35] offset:1024
    global_load_dwordx2 v[156:157], v7, s[34:35] offset:2048
    global_load_dwordx2 v[158:159], v7, s[34:35] offset:3072
    s_lshl_b32 s99, s3, 11
    s_add_u32 s32, s99, 0x6c000
    s_add_u32 s32, s30, s32
    s_addc_u32 s33, s31, 0
    v_lshlrev_b32 v5, 4, v0
    v_lshlrev_b32 v6, 7, v3
    v_lshl_add_u32 v6, v2, 4, v6
    v_lshl_add_u32 v6, s3, 9, v6
    s_waitcnt vmcnt(0)
    s_barrier
    v_perm_b32 v48, v130, v128, s96
    v_perm_b32 v49, v134, v132, s96
    v_perm_b32 v50, v138, v136, s96
    v_perm_b32 v51, v142, v140, s96
    v_perm_b32 v52, v130, v128, s97
    v_perm_b32 v53, v134, v132, s97
    v_perm_b32 v54, v138, v136, s97
    v_perm_b32 v55, v142, v140, s97
    v_perm_b32 v56, v131, v129, s96
    v_perm_b32 v57, v135, v133, s96
    v_perm_b32 v58, v139, v137, s96
    v_perm_b32 v59, v143, v141, s96
    v_perm_b32 v60, v131, v129, s97
    v_perm_b32 v61, v135, v133, s97
    v_perm_b32 v62, v139, v137, s97
    v_perm_b32 v63, v143, v141, s97
    v_perm_b32 v64, v146, v144, s96
    v_perm_b32 v65, v150, v148, s96
    v_perm_b32 v66, v154, v152, s96
    v_perm_b32 v67, v158, v156, s96
    v_perm_b32 v68, v146, v144, s97
    v_perm_b32 v69, v150, v148, s97
    v_perm_b32 v70, v154, v152, s97
    v_perm_b32 v71, v158, v156, s97
    v_perm_b32 v72, v147, v145, s96
    v_perm_b32 v73, v151, v149, s96
    v_perm_b32 v74, v155, v153, s96
    v_perm_b32 v75, v159, v157, s96
    v_perm_b32 v76, v147, v145, s97
    v_perm_b32 v77, v151, v149, s97
    v_perm_b32 v78, v155, v153, s97
    v_perm_b32 v79, v159, v157, s97
    s_barrier
    s_mov_b32 s98, 100000
L_poll9:
    global_load_dwordx4 v[8:11], v5, s[32:33] sc1
    global_load_dwordx4 v[12:15], v5, s[32:33] offset:1024 sc1
    s_sub_u32 s98, s98, 1
    s_cselect_b64 s[38:39], 0, -1
    s_waitcnt vmcnt(1)
    v_mfma_f32_16x16x32_bf16 v[16:19], v[8:11], v[48:51], 0
    v_max3_u32 v7, v8, v9, v10
    v_mfma_f32_16x16x32_bf16 v[20:23], v[8:11], v[52:55], 0
    v_mfma_f32_16x16x32_bf16 v[24:27], v[8:11], v[56:59], 0
    v_mfma_f32_16x16x32_bf16 v[28:31], v[8:11], v[60:63], 0
    s_waitcnt vmcnt(0)
    v_mfma_f32_16x16x32_bf16 v[16:19], v[12:15], v[64:67], v[16:19]
    v_max3_u32 v7, v7, v11, v12
    v_mfma_f32_16x16x32_bf16 v[20:23], v[12:15], v[68:71], v[20:23]
    v_max3_u32 v7, v7, v13, v14
    v_mfma_f32_16x16x32_bf16 v[24:27], v[12:15], v[72:75], v[24:27]
    v_max_u32 v7, v7, v15
    v_mfma_f32_16x16x32_bf16 v[28:31], v[12:15], v[76:79], v[28:31]
    v_cmp_eq_u32 vcc, -1, v7
    s_and_b64 vcc, vcc, s[38:39]
    s_cbranch_scc1 L_poll9
    v_add_f32_dpp v32, v17, v16 row_shl:4 row_mask:0xf bank_mask:0xf
    v_add_f32_dpp v36, v19, v18 row_shl:4 row_mask:0xf bank_mask:0xf
    v_add_f32_dpp v33, v21, v20 row_shl:4 row_mask:0xf bank_mask:0xf
    v_add_f32_dpp v37, v23, v22 row_shl:4 row_mask:0xf bank_mask:0xf
    v_add_f32_dpp v34, v25, v24 row_shl:4 row_mask:0xf bank_mask:0xf
    v_add_f32_dpp v38, v27, v26 row_shl:4 row_mask:0xf bank_mask:0xf
    v_add_f32_dpp v35, v29, v28 row_shl:4 row_mask:0xf bank_mask:0xf
    v_add_f32_dpp v39, v31, v30 row_shl:4 row_mask:0xf bank_mask:0xf
    s_mov_b32 exec_lo, 0xf000f
    s_mov_b32 exec_hi, 0xf000f00
    ds_write_b128 v6, v[32:35] offset:10240
    ds_write_b128 v6, v[36:39] offset:10304
    s_waitcnt lgkmcnt(0)
    s_barrier
    s_endpgm
L_DN7:
    s_barrier
    s_barrier
    s_lshr_b32 s40, s15, 1
    s_lshl2_add_u32 s41, s14, s40
    s_lshl_b32 s99, s14, 9
    s_and_b32 s42, s40, 1
    s_lshl_b32 s42, s42, 5
    s_add_u32 s99, s99, s42
    s_and_b32 s42, s40, 2
    s_lshl2_add_u32 s99, s42, s99
    s_add_u32 s34, s99, 0x63000
    s_add_u32 s34, s30, s34
    s_addc_u32 s35, s31, 0
    s_lshl_b32 s42, s14, 9
    s_add_u32 s99, s99, s42
    s_add_u32 s32, s99, 0x70000
    s_add_u32 s32, s30, s32
    s_addc_u32 s33, s31, 0
    v_and_b32 v7, 4, v0
    v_lshlrev_b32 v5, 6, v7
    v_lshl_add_u32 v5, v3, 6, v5
    v_and_b32 v7, 10, v0
    v_lshl_add_u32 v5, v7, 1, v5
    v_and_b32 v7, 0x1c0, v5
    v_add_u32 v12, v7, v5
    s_lshl_b32 s99, s41, 5
    s_add_u32 s36, s26, s99
    s_addc_u32 s37, s27, 0
    v_and_b32 v7, 15, v0
    v_lshlrev_b32 v11, 10, v3
    v_lshl_add_u32 v11, v7, 1, v11
    v_and_b32 v7, 1, v0
    v_lshlrev_b32 v7, 4, v7
    v_lshlrev_b32 v6, 2, v0
    s_mov_b32 s98, 100000
L_poll10:
    global_load_dword v8, v12, s[32:33] sc1
    global_load_dword v9, v5, s[34:35] sc1
    s_sub_u32 s98, s98, 1
    s_cselect_b64 s[38:39], 0, -1
    s_waitcnt vmcnt(0)
    v_max_u32 v10, v8, v9
    v_cmp_eq_u32 vcc, -1, v10
    s_and_b64 vcc, vcc, s[38:39]
    s_cbranch_scc1 L_poll10
    s_barrier
    v_lshrrev_b32 v8, v7, v8
    v_lshrrev_b32 v9, v7, v9
    v_lshlrev_b32 v8, 16, v8
    v_lshlrev_b32 v9, 16, v9
    s_cmp_lg_u32 s2, 8
    s_cbranch_scc1 L_DNe
    v_mov_b32 v10, s28
    s_mov_b64 exec, 1
    global_store_dword v4, v10, s[30:31] sc1
    s_mov_b64 exec, -1
L_DNe:
    s_barrier
    ds_read2st64_b32 v[16:17], v6 offset0:40 offset1:41
    ds_read2st64_b32 v[18:19], v6 offset0:42 offset1:43
    ds_read2st64_b32 v[20:21], v6 offset0:44 offset1:45
    ds_read2st64_b32 v[22:23], v6 offset0:46 offset1:47
    ds_read2st64_b32 v[24:25], v6 offset0:48 offset1:49
    ds_read2st64_b32 v[26:27], v6 offset0:50 offset1:51
    ds_read2st64_b32 v[28:29], v6 offset0:52 offset1:53
    s_waitcnt lgkmcnt(3)
    v_pk_add_f32 v[16:17], v[16:17], v[18:19]
    v_pk_add_f32 v[20:21], v[20:21], v[22:23]
    v_pk_add_f32 v[16:17], v[16:17], v[20:21]
    s_waitcnt lgkmcnt(0)
    v_pk_add_f32 v[24:25], v[24:25], v[26:27]
    v_pk_add_f32 v[16:17], v[16:17], v[28:29]
    v_pk_add_f32 v[16:17], v[16:17], v[24:25]
    v_add_f32 v16, v16, v17
    v_fma_f32 v16, v9, v16, v8
    v_cvt_pk_bf16_f32 v16, v16, v16
    global_store_short v11, v16, s[36:37]
    s_endpgm
.p2align 12
L_A2:
    s_mov_b32 s14, s40
    s_mov_b32 s15, s41
    s_mov_b32 s96, 0x05040100
    s_mov_b32 s97, 0x07060302
    s_lshl_b32 s99, s3, 13
    s_add_u32 s99, s99, 28672
    v_and_b32 v8, 15, v0
    v_lshl_add_u32 v10, v2, 2, v5
    v_lshl_add_u32 v10, v10, 8, s99
    v_xor_b32 v9, v3, v8
    v_xor_b32 v11, 0, v9
    v_lshl_add_u32 v108, v11, 4, v10
    v_xor_b32 v11, 4, v9
    v_lshl_add_u32 v109, v11, 4, v10
    v_xor_b32 v11, 8, v9
    v_lshl_add_u32 v110, v11, 4, v10
    v_xor_b32 v11, 12, v9
    v_lshl_add_u32 v111, v11, 4, v10
    v_mul_u32_u24 v6, 320, v5
    v_lshl_add_u32 v6, v3, 4, v6
    s_mul_i32 s99, s3, 2560
    v_mul_u32_u24 v7, 576, v5
    v_lshl_add_u32 v7, v2, 4, v7
    v_lshl_add_u32 v7, v3, 6, v7
    v_add_u32 v7, s99, v7
    v_lshlrev_b32 v5, 5, v5
    v_lshl_add_u32 v120, s3, 2, v5
    v_add_u32 v120, 21712, v120
    v_lshlrev_b32 v124, 4, v0
    v_add_u32 v125, 0x1000, v124
    s_lshl2_add_u32 s99, s14, s3
    s_lshl_b32 s99, s99, 8
    s_add_u32 s99, s99, s15
    s_lshl_b32 s99, s99, 4
    s_add_u32 s6, s99, 0x73000
    s_add_u32 s6, s30, s6
    s_addc_u32 s7, s31, 0
    v_and_b32 v121, 32, v0
    v_lshlrev_b32 v121, 6, v121
    v_and_b32 v122, 6, v0
    v_lshl_add_u32 v121, v122, 8, v121
    v_and_b32 v122, 16, v0
    v_lshl_add_u32 v121, v122, 4, v121
    v_and_b32 v122, 8, v0
    v_add_u32 v121, v122, v121
    v_and_b32 v122, 1, v0
    v_lshl_add_u32 v121, v122, 2, v121
    s_mul_i32 s99, s3, 576
    v_lshl_add_u32 v122, v0, 3, s99
    s_and_b32 s43, s3, 3
    s_lshl_b32 s99, s43, 8
    s_add_u32 s8, s4, s99
    s_addc_u32 s9, s5, 0
    s_lshl_b32 s99, s43, 10
    s_add_u32 s10, s99, 0x61000
    s_add_u32 s10, s30, s10
    s_addc_u32 s11, s31, 0
    v_lshrrev_b32 v119, 1, v3
    v_lshlrev_b32 v119, 7, v119
    v_and_b32 v14, 1, v3
    v_lshl_add_u32 v119, v14, 3, v119
    v_lshl_add_u32 v119, v2, 4, v119
    v_lshl_add_u32 v119, v5, 5, v119
    v_cmp_ne_u32 s[20:21], 0, v2
    v_cmp_ne_u32 s[22:23], 1, v2
    v_cmp_ne_u32 s[24:25], 2, v2
    v_cmp_ne_u32 s[26:27], 3, v2
    v_mov_b32 v123, 0
    s_min_u32 s40, s15, 13
    s_mul_i32 s99, s14, 14
    s_add_u32 s99, s99, s40
    s_lshl_b32 s99, s99, 5
    s_mul_i32 s40, s43, 458752
    s_add_u32 s99, s99, s40
    s_add_u32 s99, s99, 3584
    v_lshrrev_b32 v8, 1, v3
    v_and_b32 v9, 1, v3
    v_lshlrev_b32 v8, 6, v8
    v_lshl_add_u32 v8, v9, 2, v8
    v_and_b32 v9, 3, v1
    v_lshl_add_u32 v8, v9, 3, v8
    v_mul_u32_u24 v10, 3584, v8
    v_and_b32 v9, 1, v2
    v_lshl_add_u32 v10, v9, 4, v10
    v_add_u32 v10, s99, v10
    v_mov_b32 v11, 0
    v_cmp_lt_u32 vcc, 1, v2
    v_mov_b32 v176, s16
    v_mov_b32 v177, s17
    v_mov_b32 v178, s18
    v_mov_b32 v179, s19
    v_cndmask_b32 v176, v176, v178, vcc
    v_cndmask_b32 v177, v177, v179, vcc
    v_lshl_add_u64 v[176:177], v[10:11], 0, v[176:177]
    v_mov_b32 v10, 7168
    v_lshl_add_u64 v[178:179], v[10:11], 0, v[176:177]
    v_mov_b32 v10, 114688
    v_lshl_add_u64 v[180:181], v[10:11], 0, v[176:177]
    v_lshl_add_u64 v[182:183], v[10:11], 0, v[178:179]
    v_lshlrev_b32 v184, 2, v0
    v_add_u32 v184, 21712, v184
    v_lshlrev_b32 v185, 4, v0
    s_lshl_b32 s99, s14, 6
    s_add_u32 s99, s99, s15
    s_lshl_b32 s99, s99, 3
    s_add_u32 s99, s99, 0x72000
    v_add_u32 v185, s99, v185
    s_cmp_lg_u32 s3, 4
    s_cbranch_scc1 L_wm11
    s_call_b64 s[58:59], L_s0
L_wm11:
    s_cmp_lg_u32 s3, 5
    s_cbranch_scc1 L_wm12
    s_call_b64 s[58:59], L_s1
L_wm12:
    s_cmp_lg_u32 s3, 6
    s_cbranch_scc1 L_wm13
    s_call_b64 s[58:59], L_s2
L_wm13:
    s_cmp_lg_u32 s3, 7
    s_cbranch_scc1 L_wm14
    s_call_b64 s[58:59], L_s3
L_wm14:
    v_and_b32 v8, 15, v0
    v_and_b32 v9, 1, v3
    v_lshlrev_b32 v10, 1, v9
    v_xor_b32 v8, v10, v8
    v_lshlrev_b32 v8, 4, v8
    v_lshl_add_u32 v48, v3, 8, v8
    v_xor_b32 v49, 64, v48
    v_xor_b32 v50, 128, v48
    v_xor_b32 v51, 192, v48
    s_lshl_b32 s99, s3, 13
    s_add_u32 s99, s99, 94208
    v_and_b32 v8, 3, v1
    v_lshl_add_u32 v10, v8, 2, v3
    v_lshl_add_u32 v10, v10, 8, s99
    v_lshl_add_u32 v9, v8, 1, v9
    v_lshl_add_u32 v10, v9, 5, v10
    v_lshl_add_u32 v56, v2, 3, v10
    v_xor_b32 v57, 32, v56
    v_xor_b32 v58, 64, v56
    v_xor_b32 v59, 96, v56
    v_xor_b32 v60, 128, v56
    v_xor_b32 v61, 160, v56
    v_xor_b32 v62, 192, v56
    v_xor_b32 v63, 224, v56
    s_mov_b32 m0, s99
    s_nop 0
    global_load_lds_dwordx4 v48, s[34:35] offset:0 nt
    global_load_lds_dwordx4 v49, s[34:35] offset:1024 nt
    global_load_lds_dwordx4 v50, s[34:35] offset:2048 nt
    global_load_lds_dwordx4 v51, s[34:35] offset:3072 nt
    s_add_u32 m0, m0, 4096
    s_add_u32 s34, s34, 4096
    s_addc_u32 s35, s35, 0
    global_load_lds_dwordx4 v48, s[34:35] offset:0 nt
    global_load_lds_dwordx4 v49, s[34:35] offset:1024 nt
    global_load_lds_dwordx4 v50, s[34:35] offset:2048 nt
    global_load_lds_dwordx4 v51, s[34:35] offset:3072 nt
    s_waitcnt vmcnt(12)
    ds_read_b128 v[16:19], v108 offset:0
    ds_read_b128 v[20:23], v109 offset:0
    ds_read_b128 v[24:27], v110 offset:0
    ds_read_b128 v[28:31], v111 offset:0
    s_waitcnt vmcnt(8)
    ds_read_b128 v[32:35], v108 offset:4096
    ds_read_b128 v[36:39], v109 offset:4096
    ds_read_b128 v[40:43], v110 offset:4096
    ds_read_b128 v[44:47], v111 offset:4096
    s_cmp_lt_u32 s3, 4
    s_cbranch_scc1 L_A2b
    s_cmp_ge_u32 s3, 7
    s_cbranch_scc1 L_A3
    s_bitcmp1_b32 s3, 0
    s_cselect_b64 s[0:1], s[18:19], s[16:17]
    s_and_b32 s99, s3, 2
    s_lshl2_add_u32 s99, s15, s99
    s_mul_i32 s99, s99, 28672
    s_mul_i32 s40, s14, 448
    s_andn2_b32 s40, s40, 127
    s_add_u32 s99, s99, s40
    v_mul_u32_u24 v13, 3584, v1
    v_lshl_add_u32 v13, v2, 7, v13
    v_add_u32 v13, s99, v13
    global_load_dword v127, v13, s[0:1]
    s_mov_b64 exec, -1
    s_branch L_A3
L_A2b:
    v_readfirstlane_b32 s28, v12
    s_nop 1
    s_mul_i32 s28, s28, 1664525
    s_add_u32 s28, s28, 1013904223
    s_waitcnt lgkmcnt(0)
    s_getreg_b32 s99, hwreg(HW_REG_XCC_ID, 0, 4)
    s_xor_b32 s56, s28, s99
    s_mov_b32 s57, s56
    s_lshl2_add_u32 s99, s14, s3
    s_mul_i32 s99, s99, 8192
    s_add_u32 s32, s99, 0x20000
    s_add_u32 s32, s30, s32
    s_addc_u32 s33, s31, 0
    s_lshr_b32 s99, s15, 2
    s_lshl2_add_u32 s99, s14, s99
    s_lshl2_add_u32 s99, s99, s3
    s_lshl_b32 s99, s99, 8
    s_add_u32 s0, s99, 0x4000
    s_add_u32 s0, s30, s0
    s_addc_u32 s1, s31, 0
    s_mul_i32 s99, s3, 320
    v_lshl_add_u32 v112, v0, 2, s99
    v_lshlrev_b32_e64 v113, 2, s3
    v_lshl_add_u32 v117, v0, 4, s99
    s_setprio 2
    s_mov_b32 s98, 0
L_Aq:
    s_load_dwordx4 s[48:51], s[32:33], s98
    s_add_u32 s98, s98, 128
    s_waitcnt lgkmcnt(0)
    s_xor_b64 s[48:49], s[48:49], s[56:57]
    s_xor_b64 s[50:51], s[50:51], s[56:57]
    s_or_b64 s[48:49], s[48:49], s[50:51]
    s_cbranch_scc0 L_Aq_ok
    s_cmp_lt_u32 s98, 8192
    s_cbranch_scc1 L_Aq
L_Aq_fb:
    s_mov_b64 exec, -1
    s_getreg_b32 s99, hwreg(HW_REG_XCC_ID, 0, 4)
    s_xor_b32 s56, s28, s99
    s_lshr_b32 s99, s15, 2
    s_lshl2_add_u32 s99, s14, s99
    s_lshl2_add_u32 s99, s99, s3
    s_lshl_b32 s99, s99, 9
    s_add_u32 s32, s99, 0x10000
    s_add_u32 s32, s30, s32
    s_addc_u32 s33, s31, 0
    v_lshlrev_b32 v10, 3, v0
    s_mov_b32 s98, 100000
L_poll15:
    global_load_dwordx2 v[8:9], v10, s[32:33] sc1
    s_sub_u32 s98, s98, 1
    s_cselect_b64 s[12:13], 0, -1
    s_waitcnt vmcnt(0)
    v_xor_b32 v9, s56, v9
    v_cmp_lt_u32 vcc, 15, v9
    s_and_b64 vcc, vcc, s[12:13]
    s_cbranch_scc1 L_poll15
    v_cmp_ne_u32 vcc, 0, v9
    s_cmp_lg_u64 vcc, 0
    s_cselect_b32 s99, 2, 1
    v_mov_b32 v9, s99
    ds_write_b32 v112, v8 offset:20480
    s_branch L_Aq_st
L_Aq_ok:
    s_load_dwordx16 s[32:47], s[0:1], 0
    s_load_dwordx16 s[48:63], s[0:1], 64
    s_load_dwordx16 s[64:79], s[0:1], 128
    s_load_dwordx16 s[80:95], s[0:1], 192
    v_mov_b32 v9, 1
    s_waitcnt lgkmcnt(0)
    v_writelane_b32 v80, s32, 0
    v_writelane_b32 v81, s33, 0
    v_writelane_b32 v82, s34, 0
    v_writelane_b32 v83, s35, 0
    v_writelane_b32 v80, s36, 1
    v_writelane_b32 v81, s37, 1
    v_writelane_b32 v82, s38, 1
    v_writelane_b32 v83, s39, 1
    v_writelane_b32 v80, s40, 2
    v_writelane_b32 v81, s41, 2
    v_writelane_b32 v82, s42, 2
    v_writelane_b32 v83, s43, 2
    v_writelane_b32 v80, s44, 3
    v_writelane_b32 v81, s45, 3
    v_writelane_b32 v82, s46, 3
    v_writelane_b32 v83, s47, 3
    v_writelane_b32 v80, s48, 4
    v_writelane_b32 v81, s49, 4
    v_writelane_b32 v82, s50, 4
    v_writelane_b32 v83, s51, 4
    v_writelane_b32 v80, s52, 5
    v_writelane_b32 v81, s53, 5
    v_writelane_b32 v82, s54, 5
    v_writelane_b32 v83, s55, 5
    v_writelane_b32 v80, s56, 6
    v_writelane_b32 v81, s57, 6
    v_writelane_b32 v82, s58, 6
    v_writelane_b32 v83, s59, 6
    v_writelane_b32 v80, s60, 7
    v_writelane_b32 v81, s61, 7
    v_writelane_b32 v82, s62, 7
    v_writelane_b32 v83, s63, 7
    v_writelane_b32 v80, s64, 8
    v_writelane_b32 v81, s65, 8
    v_writelane_b32 v82, s66, 8
    v_writelane_b32 v83, s67, 8
    v_writelane_b32 v80, s68, 9
    v_writelane_b32 v81, s69, 9
    v_writelane_b32 v82, s70, 9
    v_writelane_b32 v83, s71, 9
    v_writelane_b32 v80, s72, 10
    v_writelane_b32 v81, s73, 10
    v_writelane_b32 v82, s74, 10
    v_writelane_b32 v83, s75, 10
    v_writelane_b32 v80, s76, 11
    v_writelane_b32 v81, s77, 11
    v_writelane_b32 v82, s78, 11
    v_writelane_b32 v83, s79, 11
    v_writelane_b32 v80, s80, 12
    v_writelane_b32 v81, s81, 12
    v_writelane_b32 v82, s82, 12
    v_writelane_b32 v83, s83, 12
    v_writelane_b32 v80, s84, 13
    v_writelane_b32 v81, s85, 13
    v_writelane_b32 v82, s86, 13
    v_writelane_b32 v83, s87, 13
    v_writelane_b32 v80, s88, 14
    v_writelane_b32 v81, s89, 14
    v_writelane_b32 v82, s90, 14
    v_writelane_b32 v83, s91, 14
    v_writelane_b32 v80, s92, 15
    v_writelane_b32 v81, s93, 15
    v_writelane_b32 v82, s94, 15
    v_writelane_b32 v83, s95, 15
    s_mov_b32 exec_lo, 0xffff
    s_mov_b32 exec_hi, 0x0
    ds_write_b128 v117, v[80:83] offset:20480
    s_mov_b64 exec, -1
L_Aq_st:
    ds_write_b32 v113, v9 offset:21696
    s_setprio 0
L_A3:
    s_mov_b32 s99, 0x3fb8aa3b
    s_waitcnt lgkmcnt(0)
    s_barrier
    ds_read_b128 v[88:91], v6 offset:20480
    ds_read_b128 v[92:95], v6 offset:20544
    ds_read_b128 v[96:99], v6 offset:20608
    ds_read_b128 v[100:103], v6 offset:20672
    ds_read_b128 v[12:15], v4 offset:21696
    s_waitcnt lgkmcnt(4)
    v_mfma_f32_16x16x32_bf16 v[80:83], v[16:19], v[88:91], 0
    v_mfma_f32_16x16x32_bf16 v[84:87], v[32:35], v[88:91], 0
    s_waitcnt lgkmcnt(3)
    v_mfma_f32_16x16x32_bf16 v[80:83], v[20:23], v[92:95], v[80:83]
    v_mfma_f32_16x16x32_bf16 v[84:87], v[36:39], v[92:95], v[84:87]
    s_waitcnt lgkmcnt(2)
    v_mfma_f32_16x16x32_bf16 v[80:83], v[24:27], v[96:99], v[80:83]
    v_mfma_f32_16x16x32_bf16 v[84:87], v[40:43], v[96:99], v[84:87]
    s_waitcnt lgkmcnt(0)
    v_mfma_f32_16x16x32_bf16 v[80:83], v[28:31], v[100:103], v[80:83]
    v_mfma_f32_16x16x32_bf16 v[84:87], v[44:47], v[100:103], v[84:87]
    v_or3_b32 v12, v12, v13, v14
    v_or_b32 v12, v12, v15
    v_lshrrev_b32 v12, 1, v12
    s_nop 0
    v_readfirstlane_b32 s29, v12
    s_nop 1
    v_max3_f32 v12, v80, v81, v82
    v_cndmask_b32 v112, v82, v80, s[22:23]
    v_max3_f32 v13, v83, v84, v85
    v_cndmask_b32 v113, v83, v81, s[22:23]
    v_max3_f32 v12, v12, v86, v87
    v_cndmask_b32 v112, v84, v112, s[24:25]
    v_max_f32 v12, v12, v13
    v_mov_b32 v13, v12
    v_cndmask_b32 v113, v85, v113, s[24:25]
    v_cndmask_b32 v112, v86, v112, s[26:27]
    v_permlane16_swap_b32 v13, v12
    v_cndmask_b32 v113, v87, v113, s[26:27]
    v_max_f32 v12, v12, v13
    v_mov_b32 v13, v12
    v_cvt_pk_bf16_f32 v113, v112, v113
    v_lshlrev_b32 v112, 16, v113
    v_permlane32_swap_b32 v13, v12
    v_and_b32 v113, 0xffff0000, v113
    v_max_f32 v12, v12, v13
    v_mul_f32 v112, 0x3db504f3, v112
    v_cvt_pk_bf16_f32 v12, v123, v12
    v_mul_f32 v113, 0x3db504f3, v113
    v_mul_f32 v12, 0x3db504f3, v12
    v_cvt_pk_bf16_f32 v113, v112, v113
    v_cvt_pk_bf16_f32 v12, v123, v12
    v_lshlrev_b32 v112, 16, v113
    v_mul_f32 v12, 0x3fb8aa3b, v12
    v_and_b32 v113, 0xffff0000, v113
    v_fma_f32 v112, v112, s99, -v12
    v_fma_f32 v113, v113, s99, -v12
    v_exp_f32 v112, v112
    v_exp_f32 v113, v113
    s_mov_b64 vcc, s[20:21]
    v_add_f32 v13, v112, v113
    v_cvt_pk_bf16_f32 v8, v112, v113
    s_nop 0
    v_add_f32_dpp v13, v13, v13 quad_perm:[1,0,3,2] row_mask:0xf bank_mask:0xf
    v_cndmask_b32_dpp v88, v8, v123, vcc quad_perm:[0,0,0,0] row_mask:0xf bank_mask:0xf
    v_cndmask_b32_dpp v89, v8, v123, vcc quad_perm:[1,1,1,1] row_mask:0xf bank_mask:0xf
    v_add_f32_dpp v13, v13, v13 quad_perm:[2,3,0,1] row_mask:0xf bank_mask:0xf
    v_cndmask_b32_dpp v90, v8, v123, vcc quad_perm:[2,2,2,2] row_mask:0xf bank_mask:0xf
    v_cndmask_b32_dpp v91, v8, v123, vcc quad_perm:[3,3,3,3] row_mask:0xf bank_mask:0xf
    s_mov_b64 vcc, s[22:23]
    v_mov_b32 v14, v13
    v_cndmask_b32_dpp v92, v8, v123, vcc quad_perm:[0,0,0,0] row_mask:0xf bank_mask:0xf
    v_cndmask_b32_dpp v93, v8, v123, vcc quad_perm:[1,1,1,1] row_mask:0xf bank_mask:0xf
    v_permlane16_swap_b32 v14, v13
    v_cndmask_b32_dpp v94, v8, v123, vcc quad_perm:[2,2,2,2] row_mask:0xf bank_mask:0xf
    v_cndmask_b32_dpp v95, v8, v123, vcc quad_perm:[3,3,3,3] row_mask:0xf bank_mask:0xf
    s_mov_b64 vcc, s[24:25]
    v_add_f32 v13, v13, v14
    v_cndmask_b32_dpp v96, v8, v123, vcc quad_perm:[0,0,0,0] row_mask:0xf bank_mask:0xf
    v_cndmask_b32_dpp v97, v8, v123, vcc quad_perm:[1,1,1,1] row_mask:0xf bank_mask:0xf
    v_mov_b32 v14, v13
    v_cndmask_b32_dpp v98, v8, v123, vcc quad_perm:[2,2,2,2] row_mask:0xf bank_mask:0xf
    v_cndmask_b32_dpp v99, v8, v123, vcc quad_perm:[3,3,3,3] row_mask:0xf bank_mask:0xf
    s_mov_b64 vcc, s[26:27]
    v_permlane32_swap_b32 v14, v13
    v_cndmask_b32_dpp v100, v8, v123, vcc quad_perm:[0,0,0,0] row_mask:0xf bank_mask:0xf
    v_cndmask_b32_dpp v101, v8, v123, vcc quad_perm:[1,1,1,1] row_mask:0xf bank_mask:0xf
    v_add_f32 v13, v13, v14
    v_cndmask_b32_dpp v102, v8, v123, vcc quad_perm:[2,2,2,2] row_mask:0xf bank_mask:0xf
    v_cndmask_b32_dpp v103, v8, v123, vcc quad_perm:[3,3,3,3] row_mask:0xf bank_mask:0xf
    s_mov_b32 exec_lo, 0x1111
    s_mov_b32 exec_hi, 0x0
    ds_write2_b32 v120, v12, v13 offset0:0 offset1:32
    s_mov_b64 exec, -1
    s_waitcnt lgkmcnt(0)
    s_barrier
    ds_read_b128 v[104:107], v5 offset:21712
    ds_read_b128 v[108:111], v5 offset:21728
    ds_read2_b32 v[186:187], v184 offset0:0 offset1:32
    s_cmp_lt_u32 s3, 4
    s_cbranch_scc0 L_A5
    s_waitcnt vmcnt(0)
    s_branch L_A5b
L_A5:
    global_load_dwordx2 v[128:129], v119, s[8:9]
    global_load_dwordx2 v[130:131], v119, s[8:9] offset:64
    global_load_dwordx4 v[132:135], v124, s[10:11] offset:-4096 sc1
    global_load_dwordx4 v[136:139], v124, s[10:11] sc1
    global_load_dwordx4 v[140:143], v125, s[10:11] sc1
L_A5b:
    s_sub_u32 s41, s3, 4
    s_cmp_lt_u32 s41, 3
    s_cbranch_scc1 L_A5w
    s_waitcnt vmcnt(5)
L_A5w:
    s_waitcnt vmcnt(6) lgkmcnt(0)
    ds_read_b64_tr_b16 v[144:145], v56
    ds_read_b64_tr_b16 v[146:147], v56 offset:4096
    ds_read_b64_tr_b16 v[148:149], v57
    ds_read_b64_tr_b16 v[150:151], v57 offset:4096
    ds_read_b64_tr_b16 v[152:153], v58
    ds_read_b64_tr_b16 v[154:155], v58 offset:4096
    ds_read_b64_tr_b16 v[156:157], v59
    ds_read_b64_tr_b16 v[158:159], v59 offset:4096
    ds_read_b64_tr_b16 v[160:161], v60
    ds_read_b64_tr_b16 v[162:163], v60 offset:4096
    ds_read_b64_tr_b16 v[164:165], v61
    ds_read_b64_tr_b16 v[166:167], v61 offset:4096
L_A6:
    s_waitcnt lgkmcnt(10)
    v_mfma_f32_16x16x32_bf16 v[80:83], v[144:147], v[88:91], 0
    ds_read_b64_tr_b16 v[168:169], v62
    ds_read_b64_tr_b16 v[170:171], v62 offset:4096
    v_max_f32_dpp v188, v186, v186 quad_perm:[1,0,3,2] row_mask:0xf bank_mask:0xf
    v_max3_f32 v14, v104, v105, v106
    s_waitcnt lgkmcnt(10)
    v_mfma_f32_16x16x32_bf16 v[80:83], v[148:151], v[92:95], v[80:83]
    ds_read_b64_tr_b16 v[172:173], v63
    ds_read_b64_tr_b16 v[174:175], v63 offset:4096
    v_max_f32_dpp v188, v188, v188 quad_perm:[2,3,0,1] row_mask:0xf bank_mask:0xf
    v_max3_f32 v15, v107, v108, v109
    s_waitcnt lgkmcnt(10)
    v_mfma_f32_16x16x32_bf16 v[80:83], v[152:155], v[96:99], v[80:83]
    v_max_f32_dpp v188, v188, v188 row_half_mirror row_mask:0xf bank_mask:0xf
    v_max3_f32 v14, v14, v110, v111
    s_waitcnt lgkmcnt(8)
    v_mfma_f32_16x16x32_bf16 v[80:83], v[156:159], v[100:103], v[80:83]
    v_sub_f32 v186, v186, v188
    v_max_f32 v14, v14, v15
    s_waitcnt lgkmcnt(6)
    v_mfma_f32_16x16x32_bf16 v[84:87], v[160:163], v[88:91], 0
    v_exp_f32 v186, v186
    v_sub_f32 v10, v12, v14
    s_waitcnt lgkmcnt(4)
    v_mfma_f32_16x16x32_bf16 v[84:87], v[164:167], v[92:95], v[84:87]
    v_mul_f32 v189, v186, v187
    v_exp_f32 v10, v10
    s_waitcnt lgkmcnt(2)
    v_mfma_f32_16x16x32_bf16 v[84:87], v[168:171], v[96:99], v[84:87]
    v_add_f32_dpp v189, v189, v189 quad_perm:[1,0,3,2] row_mask:0xf bank_mask:0xf
    s_waitcnt lgkmcnt(0)
    v_mfma_f32_16x16x32_bf16 v[84:87], v[172:175], v[100:103], v[84:87]
    v_pk_mul_f32 v[80:81], v[80:81], v[10:11] op_sel_hi:[1,0]
    v_pk_mul_f32 v[82:83], v[82:83], v[10:11] op_sel_hi:[1,0]
    v_add_f32_dpp v189, v189, v189 quad_perm:[2,3,0,1] row_mask:0xf bank_mask:0xf
    ds_write_b128 v7, v[80:83]
    s_nop 0
    v_add_f32_dpp v189, v189, v189 row_half_mirror row_mask:0xf bank_mask:0xf
    s_nop 1
    v_pk_mul_f32 v[84:85], v[84:85], v[10:11] op_sel_hi:[1,0]
    v_pk_mul_f32 v[86:87], v[86:87], v[10:11] op_sel_hi:[1,0]
    ds_write_b128 v7, v[84:87] offset:256
L_A8:
    s_waitcnt lgkmcnt(0)
    s_barrier
    s_cmp_ge_u32 s3, 4
    s_cbranch_scc1 L_A9
    ds_read2st64_b64 v[16:19], v122 offset0:0 offset1:5
    ds_read2st64_b64 v[20:23], v122 offset0:10 offset1:15
    ds_read2st64_b64 v[24:27], v122 offset0:20 offset1:25
    ds_read2st64_b64 v[28:31], v122 offset0:30 offset1:35
    s_cmp_lg_u32 s29, 0
    s_waitcnt lgkmcnt(2)
    v_pk_add_f32 v[16:17], v[16:17], v[18:19]
    v_pk_add_f32 v[20:21], v[20:21], v[22:23]
    s_waitcnt lgkmcnt(1)
    v_pk_add_f32 v[24:25], v[24:25], v[26:27]
    v_pk_add_f32 v[16:17], v[16:17], v[20:21]
    s_waitcnt lgkmcnt(0)
    v_pk_add_f32 v[28:29], v[28:29], v[30:31]
    v_pk_add_f32 v[16:17], v[16:17], v[24:25]
    v_pk_add_f32 v[16:17], v[16:17], v[28:29]
    v_cvt_pk_bf16_f32 v10, v16, v17
    s_cbranch_scc1 L_A_pubg
    global_store_dword v121, v10, s[6:7]
L_A_pubd:
    s_barrier
    s_branch L_FF0
L_A_pubg:
    global_store_dword v121, v10, s[6:7] sc1
    s_branch L_A_pubd
L_A9:
    s_cmp_lg_u32 s3, 5
    s_cbranch_scc1 L_FF
L_A7:
    s_mov_b32 exec_lo, 0x1010101
    s_mov_b32 exec_hi, 0x0
    s_cmp_lg_u32 s29, 0
    s_cbranch_scc1 L_A_mlg
    global_store_dwordx2 v185, v[188:189], s[30:31]
L_A_mld:
    s_mov_b64 exec, -1
    s_branch L_FF
L_A_mlg:
    global_store_dwordx2 v185, v[188:189], s[30:31] sc1
    s_branch L_A_mld
.p2align 12
L_s0:
    s_setpc_b64 s[58:59]
L_FF:
    s_cmp_ge_u32 s15, 14
    s_cbranch_scc1 L_fin2
    s_lshl_b32 s99, s43, 10
    v_and_b32 v9, 15, v0
    s_barrier
    global_load_dwordx4 v[16:19], v[176:177], off offset:-3584
    global_load_dwordx4 v[20:23], v[176:177], off offset:0
    global_load_dwordx4 v[24:27], v[176:177], off offset:3584
    global_load_dwordx4 v[28:31], v[178:179], off offset:0
    global_load_dwordx4 v[32:35], v[180:181], off offset:-3584
    global_load_dwordx4 v[36:39], v[180:181], off offset:0
    global_load_dwordx4 v[40:43], v[180:181], off offset:3584
    global_load_dwordx4 v[44:47], v[182:183], off offset:0
    v_lshlrev_b32 v12, 4, v9
    v_lshl_add_u32 v12, v3, 12, v12
    v_add_u32 v13, 0x4000, v12
    s_add_u32 s6, s99, 0x64000
    s_add_u32 s6, s30, s6
    s_addc_u32 s7, s31, 0
    s_lshl_b32 s40, s99, 1
    s_add_u32 s8, s40, 0x70000
    s_add_u32 s8, s30, s8
    s_addc_u32 s9, s31, 0
    s_lshr_b32 s40, s14, 1
    s_and_b32 s41, s14, 1
    s_lshl2_add_u32 s40, s41, s40
    v_and_b32 v15, 7, v1
    v_cmp_eq_u32 s[20:21], s40, v15
    s_lshl_b32 s40, s43, 9
    s_add_u32 s40, s40, 22016
    v_lshlrev_b32 v5, 7, v3
    v_lshl_add_u32 v5, v2, 5, v5
    v_add_u32 v5, s40, v5
    v_and_b32 v6, 1, v0
    v_lshlrev_b32 v6, 4, v6
    v_mov_b32 v7, 0x3f80
    v_lshlrev_b32 v6, v6, v7
    v_lshrrev_b32 v7, 1, v9
    v_cmp_eq_u32 vcc, 0, v7
    s_nop 1
    v_cndmask_b32 v120, 0, v6, vcc
    v_cmp_eq_u32 vcc, 1, v7
    s_nop 1
    v_cndmask_b32 v121, 0, v6, vcc
    v_cmp_eq_u32 vcc, 2, v7
    s_nop 1
    v_cndmask_b32 v122, 0, v6, vcc
    v_cmp_eq_u32 vcc, 3, v7
    s_nop 1
    v_cndmask_b32 v123, 0, v6, vcc
    v_cmp_eq_u32 vcc, 4, v7
    s_nop 1
    v_cndmask_b32 v92, 0, v6, vcc
    v_cmp_eq_u32 vcc, 5, v7
    s_nop 1
    v_cndmask_b32 v93, 0, v6, vcc
    v_cmp_eq_u32 vcc, 6, v7
    s_nop 1
    v_cndmask_b32 v94, 0, v6, vcc
    v_cmp_eq_u32 vcc, 7, v7
    s_nop 1
    v_cndmask_b32 v95, 0, v6, vcc
    s_lshl_b32 s40, s43, 2
    s_add_u32 s40, s40, 28160
    v_and_b32 v6, 3, v1
    v_lshlrev_b32 v6, 5, v6
    v_lshl_add_u32 v6, v3, 3, v6
    v_add_u32 v6, s40, v6
    s_waitcnt vmcnt(8)
    v_max3_u32 v14, v132, v133, v134
    v_max3_u32 v14, v14, v135, v136
    v_max3_u32 v14, v14, v137, v138
    v_max3_u32 v14, v14, v139, v140
    v_max3_u32 v14, v14, v141, v142
    v_max_u32 v14, v14, v143
    v_cmp_eq_u32 vcc, -1, v14
    s_cbranch_vccz L_FF1
    s_mov_b32 s98, 100000
L_poll16:
    global_load_dwordx4 v[132:135], v124, s[10:11] offset:-4096 sc1
    global_load_dwordx4 v[136:139], v124, s[10:11] sc1
    global_load_dwordx4 v[140:143], v125, s[10:11] sc1
    s_sub_u32 s98, s98, 1
    s_cselect_b64 s[12:13], 0, -1
    s_waitcnt vmcnt(0)
    v_max3_u32 v14, v132, v133, v134
    v_max3_u32 v14, v14, v135, v136
    v_max3_u32 v14, v14, v137, v138
    v_max3_u32 v14, v14, v139, v140
    v_max3_u32 v14, v14, v141, v142
    v_max_u32 v14, v14, v143
    v_cmp_eq_u32 vcc, -1, v14
    s_and_b64 vcc, vcc, s[12:13]
    s_cbranch_scc1 L_poll16
L_FF1:
    v_lshlrev_b32 v124, 7, v1
    v_lshl_add_u32 v124, v2, 4, v124
    v_lshlrev_b32 v96, 16, v128
    v_and_b32 v97, 0xffff0000, v128
    v_lshlrev_b32 v98, 16, v129
    v_and_b32 v99, 0xffff0000, v129
    v_lshlrev_b32 v100, 16, v130
    v_and_b32 v101, 0xffff0000, v130
    v_lshlrev_b32 v102, 16, v131
    v_and_b32 v103, 0xffff0000, v131
    v_lshlrev_b32 v104, 16, v132
    v_and_b32 v105, 0xffff0000, v132
    v_lshlrev_b32 v106, 16, v133
    v_and_b32 v107, 0xffff0000, v133
    v_lshlrev_b32 v108, 16, v134
    v_and_b32 v109, 0xffff0000, v134
    v_lshlrev_b32 v110, 16, v135
    v_and_b32 v111, 0xffff0000, v135
    v_lshlrev_b32 v112, 16, v140
    v_and_b32 v113, 0xffff0000, v140
    v_lshlrev_b32 v114, 16, v141
    v_and_b32 v115, 0xffff0000, v141
    v_lshlrev_b32 v116, 16, v142
    v_and_b32 v117, 0xffff0000, v142
    v_lshlrev_b32 v118, 16, v143
    v_and_b32 v119, 0xffff0000, v143
    v_add_f32 v112, 1.0, v112
    v_add_f32 v113, 1.0, v113
    v_add_f32 v114, 1.0, v114
    v_add_f32 v115, 1.0, v115
    v_add_f32 v116, 1.0, v116
    v_add_f32 v117, 1.0, v117
    v_add_f32 v118, 1.0, v118
    v_add_f32 v119, 1.0, v119
    v_cvt_pk_bf16_f32 v140, v112, v113
    v_cvt_pk_bf16_f32 v141, v114, v115
    v_cvt_pk_bf16_f32 v142, v116, v117
    v_cvt_pk_bf16_f32 v143, v118, v119
    v_lshlrev_b32 v112, 16, v140
    v_and_b32 v113, 0xffff0000, v140
    v_lshlrev_b32 v114, 16, v141
    v_and_b32 v115, 0xffff0000, v141
    v_lshlrev_b32 v116, 16, v142
    v_and_b32 v117, 0xffff0000, v142
    v_lshlrev_b32 v118, 16, v143
    v_and_b32 v119, 0xffff0000, v143
    v_mul_f32 v84, v104, v112
    v_mul_f32 v85, v105, v113
    v_mul_f32 v86, v106, v114
    v_mul_f32 v87, v107, v115
    v_mul_f32 v88, v108, v116
    v_mul_f32 v89, v109, v117
    v_mul_f32 v90, v110, v118
    v_mul_f32 v91, v111, v119
    v_mul_f32 v112, v96, v112
    v_mul_f32 v113, v97, v113
    v_mul_f32 v114, v98, v114
    v_mul_f32 v115, v99, v115
    v_mul_f32 v116, v100, v116
    v_mul_f32 v117, v101, v117
    v_mul_f32 v118, v102, v118
    v_mul_f32 v119, v103, v119
    s_branch L_s1o
L_s1:
    s_setpc_b64 s[58:59]
L_s1o:
    s_waitcnt vmcnt(6)
    v_perm_b32 v48, v20, v16, s96
    v_perm_b32 v52, v20, v16, s97
    v_perm_b32 v56, v21, v17, s96
    v_perm_b32 v60, v21, v17, s97
    v_perm_b32 v64, v22, v18, s96
    v_perm_b32 v68, v22, v18, s97
    v_perm_b32 v72, v23, v19, s96
    v_perm_b32 v76, v23, v19, s97
    s_waitcnt vmcnt(4)
    v_perm_b32 v49, v28, v24, s96
    v_perm_b32 v53, v28, v24, s97
    v_perm_b32 v57, v29, v25, s96
    v_perm_b32 v61, v29, v25, s97
    v_perm_b32 v65, v30, v26, s96
    v_perm_b32 v69, v30, v26, s97
    v_perm_b32 v73, v31, v27, s96
    v_perm_b32 v77, v31, v27, s97
    s_waitcnt vmcnt(2)
    v_perm_b32 v50, v36, v32, s96
    v_perm_b32 v54, v36, v32, s97
    v_perm_b32 v58, v37, v33, s96
    v_perm_b32 v62, v37, v33, s97
    v_perm_b32 v66, v38, v34, s96
    v_perm_b32 v70, v38, v34, s97
    v_perm_b32 v74, v39, v35, s96
    v_perm_b32 v78, v39, v35, s97
    s_waitcnt vmcnt(0)
    v_perm_b32 v51, v44, v40, s96
    v_perm_b32 v55, v44, v40, s97
    v_perm_b32 v59, v45, v41, s96
    v_perm_b32 v63, v45, v41, s97
    v_perm_b32 v67, v46, v42, s96
    v_perm_b32 v71, v46, v42, s97
    v_perm_b32 v75, v47, v43, s96
    v_perm_b32 v79, v47, v43, s97
    s_barrier
    v_mfma_f32_16x16x32_bf16 v[144:147], v[136:139], v[48:51], 0
    v_mfma_f32_16x16x32_bf16 v[148:151], v[136:139], v[52:55], 0
    v_mfma_f32_16x16x32_bf16 v[152:155], v[136:139], v[56:59], 0
    v_mfma_f32_16x16x32_bf16 v[156:159], v[136:139], v[60:63], 0
    v_mfma_f32_16x16x32_bf16 v[160:163], v[136:139], v[64:67], 0
    v_mfma_f32_16x16x32_bf16 v[164:167], v[136:139], v[68:71], 0
    v_mfma_f32_16x16x32_bf16 v[168:171], v[136:139], v[72:75], 0
    v_mfma_f32_16x16x32_bf16 v[172:175], v[136:139], v[76:79], 0
    v_mfma_f32_16x16x32_bf16 v[176:179], v[140:143], v[48:51], 0
    v_add_f32_dpp v128, v145, v144 row_shl:4 row_mask:0xf bank_mask:0xf
    v_add_f32_dpp v129, v149, v148 row_shl:4 row_mask:0xf bank_mask:0xf
    v_mfma_f32_16x16x32_bf16 v[180:183], v[140:143], v[52:55], 0
    v_add_f32_dpp v130, v153, v152 row_shl:4 row_mask:0xf bank_mask:0xf
    v_add_f32_dpp v131, v157, v156 row_shl:4 row_mask:0xf bank_mask:0xf
    v_mfma_f32_16x16x32_bf16 v[184:187], v[140:143], v[56:59], 0
    v_add_f32_dpp v132, v161, v160 row_shl:4 row_mask:0xf bank_mask:0xf
    v_add_f32_dpp v133, v165, v164 row_shl:4 row_mask:0xf bank_mask:0xf
    v_mfma_f32_16x16x32_bf16 v[188:191], v[140:143], v[60:63], 0
    v_add_f32_dpp v134, v169, v168 row_shl:4 row_mask:0xf bank_mask:0xf
    v_add_f32_dpp v135, v173, v172 row_shl:4 row_mask:0xf bank_mask:0xf
    v_mfma_f32_16x16x32_bf16 v[192:195], v[140:143], v[64:67], 0
    v_add_f32_dpp v128, v146, v128 row_shl:8 row_mask:0xf bank_mask:0xf
    v_add_f32_dpp v129, v150, v129 row_shl:8 row_mask:0xf bank_mask:0xf
    v_mfma_f32_16x16x32_bf16 v[196:199], v[140:143], v[68:71], 0
    v_add_f32_dpp v130, v154, v130 row_shl:8 row_mask:0xf bank_mask:0xf
    v_add_f32_dpp v131, v158, v131 row_shl:8 row_mask:0xf bank_mask:0xf
    v_mfma_f32_16x16x32_bf16 v[200:203], v[140:143], v[72:75], 0
    v_add_f32_dpp v132, v162, v132 row_shl:8 row_mask:0xf bank_mask:0xf
    v_add_f32_dpp v133, v166, v133 row_shl:8 row_mask:0xf bank_mask:0xf
    v_mfma_f32_16x16x32_bf16 v[204:207], v[140:143], v[76:79], 0
    v_add_f32_dpp v134, v170, v134 row_shl:8 row_mask:0xf bank_mask:0xf
    v_add_f32_dpp v135, v174, v135 row_shl:8 row_mask:0xf bank_mask:0xf
    s_barrier
    global_load_dwordx4 v[16:19], v12, s[6:7] offset:0 sc1
    global_load_dwordx4 v[20:23], v13, s[6:7] offset:0 sc1
    global_load_dwordx4 v[24:27], v12, s[6:7] offset:256 sc1
    global_load_dwordx4 v[28:31], v13, s[6:7] offset:256 sc1
    global_load_dwordx4 v[32:35], v12, s[6:7] offset:512 sc1
    global_load_dwordx4 v[36:39], v13, s[6:7] offset:512 sc1
    global_load_dwordx4 v[40:43], v12, s[6:7] offset:768 sc1
    global_load_dwordx4 v[44:47], v13, s[6:7] offset:768 sc1
    v_add_f32_dpp v128, v147, v128 row_shl:12 row_mask:0xf bank_mask:0xf
    v_add_f32_dpp v129, v151, v129 row_shl:12 row_mask:0xf bank_mask:0xf
    v_add_f32_dpp v130, v155, v130 row_shl:12 row_mask:0xf bank_mask:0xf
    v_add_f32_dpp v131, v159, v131 row_shl:12 row_mask:0xf bank_mask:0xf
    v_add_f32_dpp v132, v163, v132 row_shl:12 row_mask:0xf bank_mask:0xf
    v_add_f32_dpp v133, v167, v133 row_shl:12 row_mask:0xf bank_mask:0xf
    v_add_f32_dpp v134, v171, v134 row_shl:12 row_mask:0xf bank_mask:0xf
    v_add_f32_dpp v135, v175, v135 row_shl:12 row_mask:0xf bank_mask:0xf
    s_mov_b32 exec_lo, 0xf000f
    s_mov_b32 exec_hi, 0xf000f
    ds_write_b128 v5, v[128:131] offset:4096
    ds_write_b128 v5, v[132:135] offset:4112
    s_mov_b64 exec, -1
    v_add_f32_dpp v144, v177, v176 row_shl:4 row_mask:0xf bank_mask:0xf
    v_add_f32_dpp v145, v181, v180 row_shl:4 row_mask:0xf bank_mask:0xf
    v_add_f32_dpp v146, v185, v184 row_shl:4 row_mask:0xf bank_mask:0xf
    v_add_f32_dpp v147, v189, v188 row_shl:4 row_mask:0xf bank_mask:0xf
    v_add_f32_dpp v148, v193, v192 row_shl:4 row_mask:0xf bank_mask:0xf
    v_add_f32_dpp v149, v197, v196 row_shl:4 row_mask:0xf bank_mask:0xf
    v_add_f32_dpp v150, v201, v200 row_shl:4 row_mask:0xf bank_mask:0xf
    v_add_f32_dpp v151, v205, v204 row_shl:4 row_mask:0xf bank_mask:0xf
    v_add_f32_dpp v144, v178, v144 row_shl:8 row_mask:0xf bank_mask:0xf
    v_add_f32_dpp v145, v182, v145 row_shl:8 row_mask:0xf bank_mask:0xf
    v_add_f32_dpp v146, v186, v146 row_shl:8 row_mask:0xf bank_mask:0xf
    v_add_f32_dpp v147, v190, v147 row_shl:8 row_mask:0xf bank_mask:0xf
    v_add_f32_dpp v148, v194, v148 row_shl:8 row_mask:0xf bank_mask:0xf
    v_add_f32_dpp v149, v198, v149 row_shl:8 row_mask:0xf bank_mask:0xf
    v_add_f32_dpp v150, v202, v150 row_shl:8 row_mask:0xf bank_mask:0xf
    v_add_f32_dpp v151, v206, v151 row_shl:8 row_mask:0xf bank_mask:0xf
    v_add_f32_dpp v144, v179, v144 row_shl:12 row_mask:0xf bank_mask:0xf
    v_add_f32_dpp v145, v183, v145 row_shl:12 row_mask:0xf bank_mask:0xf
    v_add_f32_dpp v146, v187, v146 row_shl:12 row_mask:0xf bank_mask:0xf
    v_add_f32_dpp v147, v191, v147 row_shl:12 row_mask:0xf bank_mask:0xf
    v_add_f32_dpp v148, v195, v148 row_shl:12 row_mask:0xf bank_mask:0xf
    v_add_f32_dpp v149, v199, v149 row_shl:12 row_mask:0xf bank_mask:0xf
    v_add_f32_dpp v150, v203, v150 row_shl:12 row_mask:0xf bank_mask:0xf
    v_add_f32_dpp v151, v207, v151 row_shl:12 row_mask:0xf bank_mask:0xf
    s_mov_b32 exec_lo, 0xf000f
    s_mov_b32 exec_hi, 0xf000f
    ds_write_b128 v5, v[144:147] offset:2048
    ds_write_b128 v5, v[148:151] offset:2064
    s_mov_b64 exec, -1
    s_mov_b32 s98, 100000
    s_branch L_s2o
L_s2:
    s_setpc_b64 s[58:59]
L_s2o:
    s_waitcnt lgkmcnt(0)
    s_barrier
    s_branch L_FF2
L_poll17:
    global_load_dwordx4 v[16:19], v12, s[6:7] offset:0 sc1
    global_load_dwordx4 v[20:23], v13, s[6:7] offset:0 sc1
    global_load_dwordx4 v[24:27], v12, s[6:7] offset:256 sc1
    global_load_dwordx4 v[28:31], v13, s[6:7] offset:256 sc1
    global_load_dwordx4 v[32:35], v12, s[6:7] offset:512 sc1
    global_load_dwordx4 v[36:39], v13, s[6:7] offset:512 sc1
    global_load_dwordx4 v[40:43], v12, s[6:7] offset:768 sc1
    global_load_dwordx4 v[44:47], v13, s[6:7] offset:768 sc1
L_FF2:
    s_sub_u32 s98, s98, 1
    s_cselect_b64 s[12:13], 0, -1
    s_waitcnt vmcnt(6)
    v_mfma_f32_16x16x32_bf16 v[80:83], v[120:123], v[16:19], 0
    v_max3_u32 v14, v16, v17, v18
    v_max3_u32 v14, v14, v19, v20
    v_mfma_f32_16x16x32_bf16 v[80:83], v[120:123], v[20:23], v[80:83]
    v_max3_u32 v14, v14, v21, v22
    s_waitcnt vmcnt(4)
    v_mfma_f32_16x16x32_bf16 v[8:11], v[120:123], v[24:27], 0
    v_max3_u32 v14, v14, v23, v24
    v_max3_u32 v14, v14, v25, v26
    v_mfma_f32_16x16x32_bf16 v[8:11], v[120:123], v[28:31], v[8:11]
    v_max3_u32 v14, v14, v27, v28
    v_max3_u32 v14, v14, v29, v30
    s_waitcnt vmcnt(2)
    v_mfma_f32_16x16x32_bf16 v[80:83], v[92:95], v[32:35], v[80:83]
    v_max3_u32 v14, v14, v31, v32
    v_max3_u32 v14, v14, v33, v34
    v_mfma_f32_16x16x32_bf16 v[80:83], v[92:95], v[36:39], v[80:83]
    v_max3_u32 v14, v14, v35, v36
    v_max3_u32 v14, v14, v37, v38
    s_waitcnt vmcnt(0)
    v_mfma_f32_16x16x32_bf16 v[8:11], v[92:95], v[40:43], v[8:11]
    v_max3_u32 v14, v14, v39, v40
    v_max3_u32 v14, v14, v41, v42
    v_mfma_f32_16x16x32_bf16 v[8:11], v[92:95], v[44:47], v[8:11]
    v_max3_u32 v14, v14, v43, v44
    v_max3_u32 v14, v14, v45, v46
    v_max_u32 v14, v14, v47
    v_cmp_eq_u32 vcc, -1, v14
    s_and_b64 vcc, vcc, s[12:13]
    s_cbranch_scc1 L_poll17
    v_pk_fma_f32 v[112:113], v[80:81], v[84:85], v[112:113]
    v_pk_fma_f32 v[114:115], v[82:83], v[86:87], v[114:115]
    v_pk_fma_f32 v[116:117], v[8:9], v[88:89], v[116:117]
    v_pk_fma_f32 v[118:119], v[10:11], v[90:91], v[118:119]
    v_cvt_pk_bf16_f32 v84, v112, v113
    v_cvt_pk_bf16_f32 v85, v114, v115
    v_cvt_pk_bf16_f32 v86, v116, v117
    v_cvt_pk_bf16_f32 v87, v118, v119
    s_nop 1
    v_mfma_f32_16x16x32_bf16 v[16:19], v[84:87], v[48:51], 0
    v_pk_fma_f32 v[96:97], v[80:81], v[104:105], v[96:97]
    v_pk_fma_f32 v[98:99], v[82:83], v[106:107], v[98:99]
    v_mfma_f32_16x16x32_bf16 v[20:23], v[84:87], v[52:55], 0
    v_pk_fma_f32 v[100:101], v[8:9], v[108:109], v[100:101]
    v_pk_fma_f32 v[102:103], v[10:11], v[110:111], v[102:103]
    s_cmp_eq_u32 s15, 13
    s_cbranch_scc1 L_FFx
L_FF3:
    v_mfma_f32_16x16x32_bf16 v[24:27], v[84:87], v[56:59], 0
    v_pk_mul_f32 v[8:9], v[96:97], v[96:97]
    v_pk_add_f32 v[14:15], v[96:97], v[98:99]
    v_mfma_f32_16x16x32_bf16 v[28:31], v[84:87], v[60:63], 0
    v_pk_fma_f32 v[8:9], v[98:99], v[98:99], v[8:9]
    v_pk_fma_f32 v[8:9], v[100:101], v[100:101], v[8:9]
    v_mfma_f32_16x16x32_bf16 v[32:35], v[84:87], v[64:67], 0
    v_pk_add_f32 v[14:15], v[14:15], v[100:101]
    v_pk_fma_f32 v[8:9], v[102:103], v[102:103], v[8:9]
    v_mfma_f32_16x16x32_bf16 v[36:39], v[84:87], v[68:71], 0
    v_pk_add_f32 v[14:15], v[14:15], v[102:103]
    v_add_f32 v8, v8, v9
    v_mfma_f32_16x16x32_bf16 v[40:43], v[84:87], v[72:75], 0
    v_add_f32 v14, v14, v15
    s_nop 1
    v_permlane32_swap_b32 v14, v8
    v_mfma_f32_16x16x32_bf16 v[44:47], v[84:87], v[76:79], 0
    v_add_f32 v14, v14, v8
    v_add_f32_dpp v104, v17, v16 row_shl:4 row_mask:0xf bank_mask:0xf
    v_add_f32_dpp v105, v21, v20 row_shl:4 row_mask:0xf bank_mask:0xf
    v_add_f32_dpp v106, v25, v24 row_shl:4 row_mask:0xf bank_mask:0xf
    v_add_f32_dpp v14, v14, v14 quad_perm:[1,0,3,2] row_mask:0xf bank_mask:0xf
    v_add_f32_dpp v107, v29, v28 row_shl:4 row_mask:0xf bank_mask:0xf
    v_add_f32_dpp v108, v33, v32 row_shl:4 row_mask:0xf bank_mask:0xf
    v_add_f32_dpp v109, v37, v36 row_shl:4 row_mask:0xf bank_mask:0xf
    v_add_f32_dpp v14, v14, v14 quad_perm:[2,3,0,1] row_mask:0xf bank_mask:0xf
    v_add_f32_dpp v104, v18, v104 row_shl:8 row_mask:0xf bank_mask:0xf
    v_add_f32_dpp v105, v22, v105 row_shl:8 row_mask:0xf bank_mask:0xf
    v_add_f32_dpp v106, v26, v106 row_shl:8 row_mask:0xf bank_mask:0xf
    v_mov_b32 v15, v14
    v_add_f32_dpp v110, v41, v40 row_shl:4 row_mask:0xf bank_mask:0xf
    v_add_f32_dpp v111, v45, v44 row_shl:4 row_mask:0xf bank_mask:0xf
    v_add_f32_dpp v107, v30, v107 row_shl:8 row_mask:0xf bank_mask:0xf
    v_add_f32_dpp v108, v34, v108 row_shl:8 row_mask:0xf bank_mask:0xf
    v_permlane16_swap_b32 v15, v14
    v_add_f32_dpp v109, v38, v109 row_shl:8 row_mask:0xf bank_mask:0xf
    v_add_f32_dpp v110, v42, v110 row_shl:8 row_mask:0xf bank_mask:0xf
    v_add_f32_dpp v111, v46, v111 row_shl:8 row_mask:0xf bank_mask:0xf
    v_add_f32 v14, v14, v15
    s_mov_b32 exec_lo, 0x1111
    s_mov_b32 exec_hi, 0x1111
    ds_write_b32 v6, v14
    s_mov_b64 exec, -1
    v_add_f32_dpp v104, v19, v104 row_shl:12 row_mask:0xf bank_mask:0xf
    v_add_f32_dpp v105, v23, v105 row_shl:12 row_mask:0xf bank_mask:0xf
    v_add_f32_dpp v106, v27, v106 row_shl:12 row_mask:0xf bank_mask:0xf
    v_add_f32_dpp v107, v31, v107 row_shl:12 row_mask:0xf bank_mask:0xf
    v_add_f32_dpp v108, v35, v108 row_shl:12 row_mask:0xf bank_mask:0xf
    v_add_f32_dpp v109, v39, v109 row_shl:12 row_mask:0xf bank_mask:0xf
    v_add_f32_dpp v110, v43, v110 row_shl:12 row_mask:0xf bank_mask:0xf
    v_add_f32_dpp v111, v47, v111 row_shl:12 row_mask:0xf bank_mask:0xf
    s_mov_b32 exec_lo, 0xf000f
    s_mov_b32 exec_hi, 0xf000f
    ds_write_b128 v5, v[104:107]
    ds_write_b128 v5, v[108:111] offset:16
    s_waitcnt lgkmcnt(2)
    s_barrier
    s_waitcnt lgkmcnt(0)
    s_barrier
L_fin2:
    s_endpgm
L_s3:
    s_setpc_b64 s[58:59]
L_FFx:
    v_cvt_pk_bf16_f32 v128, v96, v97
    v_cvt_pk_bf16_f32 v129, v98, v99
    v_cvt_pk_bf16_f32 v130, v100, v101
    v_cvt_pk_bf16_f32 v131, v102, v103
    s_mov_b64 exec, s[20:21]
    global_store_dwordx4 v124, v[128:131], s[8:9] sc1
    s_mov_b64 exec, -1
    s_branch L_FF3
L_FF0:
    s_cmp_lg_u32 s3, 0
    s_cbranch_scc1 L_fin2
    s_cmp_eq_u32 s15, 15
    s_cbranch_scc1 L_fin2
    s_add_u32 s6, s30, 0x91000
    s_addc_u32 s7, s31, 0
    v_lshlrev_b32 v5, 7, v0
    v_and_b32 v7, 0x380, v5
    v_add_u32 v7, 0x2000, v7
    s_movk_i32 s98, 60
    s_barrier
L_FFg:
    global_load_dword v8, v7, s[6:7] sc1
    s_sub_u32 s98, s98, 1
    s_cselect_b64 s[12:13], 0, -1
    s_waitcnt vmcnt(0)
    v_cmp_eq_u32 vcc, -1, v8
    s_and_b64 vcc, vcc, s[12:13]
    s_cbranch_scc1 L_FFg
    s_cmp_ge_u32 s15, 14
    s_cbranch_scc1 L_fin2
    v_bfe_u32 v8, v0, 3, 2
    v_lshlrev_b32 v5, 7, v8
    v_and_b32 v6, 7, v0
    v_lshl_add_u32 v5, v6, 3, v5
    v_lshrrev_b32 v6, 5, v0
    v_lshl_add_u32 v5, v6, 2, v5
    v_add_u32 v6, 64, v5
    v_lshlrev_b32 v8, 5, v8
    s_mul_i32 s99, s14, 14
    s_add_u32 s99, s99, s15
    s_lshl_b32 s99, s99, 7
    s_add_u32 s6, s99, 0x6c000
    s_add_u32 s6, s30, s6
    s_addc_u32 s7, s31, 0
    v_lshlrev_b32 v7, 2, v0
    s_mov_b32 s40, 0x3b000000
    s_barrier
    s_barrier
    ds_read2st64_b32 v[16:17], v5 offset0:94 offset1:96
    ds_read2st64_b32 v[18:19], v5 offset0:98 offset1:100
    ds_read2st64_b32 v[20:21], v6 offset0:94 offset1:96
    ds_read2st64_b32 v[22:23], v6 offset0:98 offset1:100
    ds_read2st64_b32 v[24:25], v5 offset0:102 offset1:104
    ds_read2st64_b32 v[26:27], v5 offset0:106 offset1:108
    ds_read2st64_b32 v[28:29], v6 offset0:102 offset1:104
    ds_read2st64_b32 v[30:31], v6 offset0:106 offset1:108
    s_waitcnt lgkmcnt(0)
    v_pk_add_f32 v[16:17], v[16:17], v[18:19]
    v_pk_add_f32 v[20:21], v[20:21], v[22:23]
    v_pk_add_f32 v[24:25], v[24:25], v[26:27]
    v_pk_add_f32 v[28:29], v[28:29], v[30:31]
    v_add_f32 v40, v16, v17
    v_add_f32 v41, v20, v21
    v_add_f32 v42, v24, v25
    v_add_f32 v43, v28, v29
    s_barrier
    ds_read_b128 v[24:27], v8 offset:28160
    ds_read_b128 v[28:31], v8 offset:28176
    s_barrier
    ds_read2st64_b32 v[16:17], v5 offset0:86 offset1:88
    ds_read2st64_b32 v[18:19], v5 offset0:90 offset1:92
    ds_read2st64_b32 v[20:21], v6 offset0:86 offset1:88
    ds_read2st64_b32 v[22:23], v6 offset0:90 offset1:92
    s_waitcnt lgkmcnt(4)
    v_pk_add_f32 v[24:25], v[24:25], v[26:27]
    v_pk_add_f32 v[28:29], v[28:29], v[30:31]
    v_add_f32 v24, v24, v25
    v_add_f32 v28, v28, v29
    v_mul_f32 v24, s40, v24
    v_mul_f32 v25, v24, v24
    v_fma_f32 v28, v28, s40, -v25
    v_max_f32 v28, 0, v28
    v_add_f32 v28, 0x3727c5ac, v28
    v_rsq_f32 v28, v28
    s_waitcnt lgkmcnt(0)
    v_pk_add_f32 v[16:17], v[16:17], v[18:19]
    v_pk_add_f32 v[20:21], v[20:21], v[22:23]
    v_add_f32 v16, v16, v17
    v_add_f32 v17, v20, v21
    v_fma_f32 v16, -v24, v40, v16
    v_fma_f32 v17, -v24, v41, v17
    v_fma_f32 v16, v16, v28, v42
    v_fma_f32 v17, v17, v28, v43
    v_mul_f32 v18, 0xbfb8aa3b, v16
    v_exp_f32 v18, v18
    v_mul_f32 v16, v16, v17
    v_add_f32 v18, 1.0, v18
    v_rcp_f32 v18, v18
    s_nop 0
    v_mul_f32 v16, v16, v18
    v_mov_b32 v17, v16
    s_nop 1
    v_permlane32_swap_b32 v16, v17
    v_cvt_pk_bf16_f32 v16, v16, v17
    s_mov_b32 exec_lo, 0xffffffff
    s_mov_b32 exec_hi, 0x0
    global_store_dword v7, v16, s[6:7] sc1
    s_endpgm
L_exit:
    s_endpgm
.section .rodata,"a"
.p2align 6
.amdhsa_kernel adaLN_cond__sliding_block_cached__swiglu_ffn__decode_kernel
  .amdhsa_next_free_vgpr 208
  .amdhsa_next_free_sgpr 102
  .amdhsa_accum_offset 208
  .amdhsa_group_segment_fixed_size 0
  .amdhsa_kernarg_size 112
  .amdhsa_user_sgpr_count 2
  .amdhsa_user_sgpr_kernarg_segment_ptr 1
  .amdhsa_system_sgpr_workgroup_id_x 1
  .amdhsa_float_denorm_mode_32 3
.end_amdhsa_kernel
```
